```python
import torch

def _softmax(x, axis=-1):
    return torch.softmax(x, dim=axis)
def _gelu(x):
    return torch.nn.functional.gelu(x, approximate="tanh")
def _silu(x):
    return torch.nn.functional.silu(x)
def _sigmoid(x):
    return torch.sigmoid(x)
def _layernorm(x, axis=-1, eps=1e-5):
    m = x.mean(dim=axis, keepdim=True)
    v = x.var(dim=axis, keepdim=True, unbiased=False)
    return (x - m) / torch.sqrt(v + eps)
def _scatter_add(tgt, idx, src, axis=0):
    return tgt.clone().index_add_(axis, idx, src)
def _segment_sum(src, seg, n):
    out = torch.zeros((n,) + src.shape[1:], dtype=src.dtype)
    return out.index_add_(0, seg, src)
def _pad(x, pw):
    flat = tuple(v for pair in reversed(pw) for v in pair)
    return torch.nn.functional.pad(x, flat)

kernel_name = 'sequential_preLN__gqa_block_cached__swiglu_ffn__decode'

def setup_inputs():

    _w = (lambda a: (lambda t: t.to(torch.bfloat16) if t.is_floating_point() else t)(torch.as_tensor(a)))
    def _A_setup():
        B, Sq, D = 4, 1, 640
        Hq, Hkv, Sk, Dh = 32, 32, 4096, 192
        assert Hq % Hkv == 0, (Hq, Hkv)
        return {
            "x": _w((lambda *s: torch.randn(*s, dtype=torch.bfloat16) * 0.05)(B, Sq, D)),
            "k_cache": _w((lambda *s: torch.randn(*s, dtype=torch.bfloat16) * 3.2)(B, Hkv, Sk, Dh)),
            "v_cache": _w((lambda *s: torch.randn(*s, dtype=torch.bfloat16) * 0.4)(B, Hkv, Sk, Dh)),
            "wq": _w((lambda *s: torch.randn(*s, dtype=torch.bfloat16) * 3.2)(D, Hq * Dh) * (D ** -0.5)),
            "wo": _w((lambda *s: torch.randn(*s, dtype=torch.bfloat16) * 0.4)(Hq * Dh, D) * ((Hq * Dh) ** -0.5)),
        }
    _A_in = _A_setup()

    def _B_setup():
        B, S, D, F = 4, 1, 640, 1536
        return {
            "x": _w((lambda *s: torch.randn(*s, dtype=torch.bfloat16) * 0.05)(B, S, D)),
            "w_gate": _w((lambda *s: torch.randn(*s, dtype=torch.bfloat16) * 0.05)(D, F)),
            "w_up": _w((lambda *s: torch.randn(*s, dtype=torch.bfloat16) * 0.05)(D, F)),
            "w_down": _w((lambda *s: torch.randn(*s, dtype=torch.bfloat16) * 0.05)(F, D)),
        }
    _B_in = _B_setup()

    return {
        "A_x": _A_in["x"],
        "A_k_cache": _A_in["k_cache"],
        "A_v_cache": _A_in["v_cache"],
        "A_wq": _A_in["wq"],
        "A_wo": _A_in["wo"],
        "B_x": _B_in["x"],
        "B_w_gate": _B_in["w_gate"],
        "B_w_up": _B_in["w_up"],
        "B_w_down": _B_in["w_down"],
    }

def reference(A_x, A_k_cache, A_v_cache, A_wq, A_wo, B_x, B_w_gate, B_w_up, B_w_down):
    def _A_ref(x, k_cache, v_cache, wq, wo):
        B, Sq, D = x.shape
        Hq, Dh = 32, 192
        Hkv = k_cache.shape[1]
        rep = Hq // Hkv
        q = (lambda x, *d: x.permute(*d))((x @ wq).reshape(B, Sq, Hq, Dh), 0, 2, 1, 3)
        k = (lambda x, n, axis: torch.repeat_interleave(x, n, dim=axis))(k_cache, rep, axis=1)
        v = (lambda x, n, axis: torch.repeat_interleave(x, n, dim=axis))(v_cache, rep, axis=1)
        scores = torch.einsum("bhqd,bhkd->bhqk", q, k) * (Dh ** -0.5)
        p = _softmax(scores, axis=-1)
        o = torch.einsum("bhqk,bhkd->bhqd", p, v)
        return (lambda x, *d: x.permute(*d))(o, 0, 2, 1, 3).reshape(B, Sq, Hq * Dh) @ wo

    def _B_ref(x, w_gate, w_up, w_down):
        g = _silu(x @ w_gate)
        u = x @ w_up
        return (g * u) @ w_down

    x = A_x
    h = x + _A_ref(_layernorm(x, axis=-1), A_k_cache, A_v_cache, A_wq, A_wo)
    h2 = h + _B_ref(_layernorm(h, axis=-1), B_w_gate, B_w_up, B_w_down)
    return h2
```

```asm
; @launch grid=(256,1,1) block=(512,1,1) lds=118784
.amdgcn_target "amdgcn-amd-amdhsa--gfx950"
.text
.globl sequential_preLN__gqa_block_cached__swiglu_ffn__decode_kernel
.p2align 8
.type sequential_preLN__gqa_block_cached__swiglu_ffn__decode_kernel,@function
sequential_preLN__gqa_block_cached__swiglu_ffn__decode_kernel:
    s_cmp_ge_u32 s2, 256
    s_cbranch_scc1 L_end
    s_load_dwordx16 s[64:79], s[0:1], 0
    s_load_dwordx8 s[80:87], s[0:1], 64
    s_getreg_b32 s61, hwreg(HW_REG_XCC_ID)
    v_lshrrev_b32 v7, 6, v0
    v_and_b32 v1, 63, v0
    v_readfirstlane_b32 s3, v7
    v_lshrrev_b32 v2, 3, v1
    v_and_b32 v3, 7, v1
    v_lshlrev_b32 v7, 4, v3
    v_mov_b32 v8, 384
    v_mad_u32_u24 v4, v2, v8, v7
    v_lshlrev_b32 v5, 3, v1
    v_lshlrev_b32 v6, 2, v1
    s_and_b32 s57, s2, 7
    s_lshr_b32 s44, s2, 3
    s_lshr_b32 s58, s57, 1
    s_xor_b32 s59, s58, s57
    s_and_b32 s59, s59, 1
    s_lshl_b32 s59, s59, 1
    s_and_b32 s58, s58, 1
    s_add_u32 s59, s59, s58
    s_and_b32 s57, s57, 4
    s_add_u32 s57, s57, s59
    s_lshl_b32 s2, s44, 3
    s_add_u32 s2, s2, s57
    s_lshr_b32 s58, s57, 1
    s_and_b32 s59, s44, 3
    s_cmp_gt_u32 s59, s58
    s_cselect_b32 s46, 1, 0
    s_sub_u32 s46, s59, s46
    s_lshr_b32 s60, s44, 2
    s_add_u32 s60, s60, s58
    s_xor_b32 s60, s60, s57
    s_and_b32 s60, s60, 1
    s_cmp_gt_u32 s58, s59
    s_cselect_b32 s43, 2, 3
    s_add_u32 s43, s43, s58
    s_cmp_lg_u32 s60, 0
    s_cselect_b32 s46, s43, s46
    s_and_b32 s60, s57, 1
    s_add_u32 s60, s60, 6
    s_cmp_eq_u32 s59, s58
    s_cselect_b32 s46, s60, s46
    s_lshl_b32 s58, s3, 8
    v_add_u32 v7, s58, v1
    v_add_u32 v8, 0, v7
    v_min_u32 v8, 1919, v8
    v_mul_u32_u24 v9, 0xaaab, v8
    v_lshrrev_b32 v9, 20, v9
    v_mul_u32_u24 v10, 24, v9
    v_sub_u32 v10, v8, v10
    v_mul_u32_u24 v9, 12288, v9
    v_lshl_add_u32 v52, v10, 4, v9
    v_add_u32 v8, 64, v7
    v_min_u32 v8, 1919, v8
    v_mul_u32_u24 v9, 0xaaab, v8
    v_lshrrev_b32 v9, 20, v9
    v_mul_u32_u24 v10, 24, v9
    v_sub_u32 v10, v8, v10
    v_mul_u32_u24 v9, 12288, v9
    v_lshl_add_u32 v53, v10, 4, v9
    v_add_u32 v8, 128, v7
    v_min_u32 v8, 1919, v8
    v_mul_u32_u24 v9, 0xaaab, v8
    v_lshrrev_b32 v9, 20, v9
    v_mul_u32_u24 v10, 24, v9
    v_sub_u32 v10, v8, v10
    v_mul_u32_u24 v9, 12288, v9
    v_lshl_add_u32 v54, v10, 4, v9
    v_add_u32 v8, 192, v7
    v_min_u32 v8, 1919, v8
    v_mul_u32_u24 v9, 0xaaab, v8
    v_lshrrev_b32 v9, 20, v9
    v_mul_u32_u24 v10, 24, v9
    v_sub_u32 v10, v8, v10
    v_mul_u32_u24 v9, 12288, v9
    v_lshl_add_u32 v55, v10, 4, v9
    s_lshr_b32 s45, s57, 1
    s_lshl_b32 s47, s45, 5
    s_add_u32 s47, s47, s44
    s_and_b32 s40, s57, 1
    s_lshl_b32 s40, s40, 3
    s_add_u32 s40, s40, s3
    s_mul_i32 s42, s47, 1572864
    s_mul_i32 s49, s40, 98304
    s_add_u32 s49, s49, s42
    s_and_b32 s58, s57, 1
    s_mul_i32 s49, s58, 786432
    s_mul_i32 s59, s3, 24576
    s_add_u32 s49, s49, s59
    s_add_u32 s49, s49, s42
    s_and_b32 s98, s44, 1
    s_lshl_b32 s98, s98, 1
    s_add_u32 s99, s98, s58
    s_and_b32 s59, s3, 3
    s_mul_i32 s59, s59, 1280
    s_mul_i32 s55, s57, 983040
    s_mul_i32 s58, s44, 384
    s_add_u32 s55, s55, s58
    s_lshl_b32 s56, s3, 12
    s_add_u32 s56, s56, 36864
    s_and_b32 s61, s61, 1
    s_waitcnt lgkmcnt(0)
    s_load_dword s52, s[86:87], 0
    s_mov_b32 s20, s64
    s_mov_b32 s21, s65
    s_mov_b32 s22, 5120
    s_mov_b32 s23, 0x00020000
    s_mov_b32 s12, s70
    s_mov_b32 s13, s71
    s_mov_b32 s14, 7864320
    s_mov_b32 s15, 0x00020000
    buffer_load_dword v16, v6, s[20:23], s59 offen offset:0
    buffer_load_dword v17, v6, s[20:23], s59 offen offset:256
    buffer_load_dword v18, v6, s[20:23], s59 offen offset:512
    buffer_load_dword v19, v6, s[20:23], s59 offen offset:768
    buffer_load_dword v20, v6, s[20:23], s59 offen offset:1024
    s_mov_b32 m0, s56
    s_nop 0
    buffer_load_dwordx4 v52, s[12:15], s55 offen nt lds
    s_add_u32 s56, s56, 1024
    s_mov_b32 m0, s56
    s_nop 0
    buffer_load_dwordx4 v53, s[12:15], s55 offen nt lds
    s_add_u32 s56, s56, 1024
    s_mov_b32 m0, s56
    s_nop 0
    buffer_load_dwordx4 v54, s[12:15], s55 offen nt lds
    s_add_u32 s56, s56, 1024
    s_mov_b32 m0, s56
    s_nop 0
    buffer_load_dwordx4 v55, s[12:15], s55 offen nt lds
    s_mov_b32 s4, s66
    s_mov_b32 s5, s67
    s_mov_b32 s6, 201326592
    s_mov_b32 s7, 0x00020000
    s_barrier
    s_add_u32 s48, s99, 0
    s_and_b32 s48, s48, 3
    s_mul_i32 s48, s48, 196608
    s_add_u32 s48, s48, s49
    buffer_load_dwordx4 v[112:115], v4, s[4:7], s48 offen offset:0 nt
    buffer_load_dwordx4 v[116:119], v4, s[4:7], s48 offen offset:128 nt
    buffer_load_dwordx4 v[120:123], v4, s[4:7], s48 offen offset:256 nt
    s_add_u32 s48, s48, 3072
    buffer_load_dwordx4 v[124:127], v4, s[4:7], s48 offen offset:0 nt
    buffer_load_dwordx4 v[128:131], v4, s[4:7], s48 offen offset:128 nt
    buffer_load_dwordx4 v[132:135], v4, s[4:7], s48 offen offset:256 nt
    s_add_u32 s48, s48, 3072
    buffer_load_dwordx4 v[136:139], v4, s[4:7], s48 offen offset:0 nt
    buffer_load_dwordx4 v[140:143], v4, s[4:7], s48 offen offset:128 nt
    buffer_load_dwordx4 v[144:147], v4, s[4:7], s48 offen offset:256 nt
    s_add_u32 s48, s48, 3072
    buffer_load_dwordx4 v[148:151], v4, s[4:7], s48 offen offset:0 nt
    buffer_load_dwordx4 v[152:155], v4, s[4:7], s48 offen offset:128 nt
    buffer_load_dwordx4 v[156:159], v4, s[4:7], s48 offen offset:256 nt
    s_add_u32 s48, s48, 3072
    s_mov_b32 s8, s68
    s_mov_b32 s9, s69
    s_mov_b32 s10, 201326592
    s_mov_b32 s11, 0x00020000
    s_mov_b32 s16, s72
    s_mov_b32 s17, s73
    s_mov_b32 s18, 7864320
    s_mov_b32 s19, 0x00020000
    s_mov_b32 s24, s86
    s_mov_b32 s25, s87
    s_mov_b32 s26, 16777216
    s_mov_b32 s27, 0x00020000
    s_mov_b32 s36, s80
    s_mov_b32 s37, s81
    s_mov_b32 s38, 1966080
    s_mov_b32 s39, 0x00020000
    s_mov_b32 s28, s82
    s_mov_b32 s29, s83
    s_mov_b32 s30, 5120
    s_mov_b32 s31, 0x00020000
    s_and_b32 s58, s3, 1
    s_cmp_eq_u32 s58, 0
    s_cselect_b32 s32, s76, s78
    s_cselect_b32 s33, s77, s79
    s_mov_b32 s34, 1966080
    s_mov_b32 s35, 0x00020000
    v_mov_b32 v8, 0
    ds_write_b32 v6, v8 offset:9728
    s_waitcnt vmcnt(16)
    v_lshlrev_b32 v22, 16, v16
    v_and_b32 v23, 0xffff0000, v16
    v_lshlrev_b32 v24, 16, v17
    v_and_b32 v25, 0xffff0000, v17
    v_lshlrev_b32 v26, 16, v18
    v_and_b32 v27, 0xffff0000, v18
    v_lshlrev_b32 v28, 16, v19
    v_and_b32 v29, 0xffff0000, v19
    v_lshlrev_b32 v30, 16, v20
    v_and_b32 v31, 0xffff0000, v20
    v_add_f32 v32, v22, v23
    v_add_f32 v32, v32, v24
    v_add_f32 v32, v32, v25
    v_add_f32 v32, v32, v26
    v_add_f32 v32, v32, v27
    v_add_f32 v32, v32, v28
    v_add_f32 v32, v32, v29
    v_add_f32 v32, v32, v30
    v_add_f32 v32, v32, v31
    s_nop 1
    v_add_f32_dpp v32, v32, v32 quad_perm:[1,0,3,2] row_mask:0xf bank_mask:0xf
    s_nop 1
    v_add_f32_dpp v32, v32, v32 quad_perm:[2,3,0,1] row_mask:0xf bank_mask:0xf
    s_nop 1
    v_add_f32_dpp v32, v32, v32 row_half_mirror row_mask:0xf bank_mask:0xf
    s_nop 1
    v_add_f32_dpp v32, v32, v32 row_mirror row_mask:0xf bank_mask:0xf
    v_mov_b32 v33, v32
    v_mov_b32 v34, v32
    s_nop 1
    v_permlane16_swap_b32 v33, v34
    v_add_f32 v32, v33, v34
    v_mov_b32 v33, v32
    v_mov_b32 v34, v32
    s_nop 1
    v_permlane32_swap_b32 v33, v34
    v_add_f32 v32, v33, v34
    v_mul_f32 v32, 0x3acccccd, v32
    v_sub_f32 v33, v22, v32
    v_mul_f32 v35, v33, v33
    v_sub_f32 v33, v23, v32
    v_fmac_f32 v35, v33, v33
    v_sub_f32 v33, v24, v32
    v_fmac_f32 v35, v33, v33
    v_sub_f32 v33, v25, v32
    v_fmac_f32 v35, v33, v33
    v_sub_f32 v33, v26, v32
    v_fmac_f32 v35, v33, v33
    v_sub_f32 v33, v27, v32
    v_fmac_f32 v35, v33, v33
    v_sub_f32 v33, v28, v32
    v_fmac_f32 v35, v33, v33
    v_sub_f32 v33, v29, v32
    v_fmac_f32 v35, v33, v33
    v_sub_f32 v33, v30, v32
    v_fmac_f32 v35, v33, v33
    v_sub_f32 v33, v31, v32
    v_fmac_f32 v35, v33, v33
    s_nop 1
    v_add_f32_dpp v35, v35, v35 quad_perm:[1,0,3,2] row_mask:0xf bank_mask:0xf
    s_nop 1
    v_add_f32_dpp v35, v35, v35 quad_perm:[2,3,0,1] row_mask:0xf bank_mask:0xf
    s_nop 1
    v_add_f32_dpp v35, v35, v35 row_half_mirror row_mask:0xf bank_mask:0xf
    s_nop 1
    v_add_f32_dpp v35, v35, v35 row_mirror row_mask:0xf bank_mask:0xf
    v_mov_b32 v33, v35
    v_mov_b32 v34, v35
    s_nop 1
    v_permlane16_swap_b32 v33, v34
    v_add_f32 v35, v33, v34
    v_mov_b32 v33, v35
    v_mov_b32 v34, v35
    s_nop 1
    v_permlane32_swap_b32 v33, v34
    v_add_f32 v35, v33, v34
    v_mul_f32 v35, 0x3acccccd, v35
    v_cvt_pk_bf16_f32 v32, v32, v32
    v_and_b32 v32, 0xffff0000, v32
    v_cvt_pk_bf16_f32 v35, v35, v35
    v_and_b32 v35, 0xffff0000, v35
    v_add_f32 v35, 0x3727c5ac, v35
    v_cvt_pk_bf16_f32 v35, v35, v35
    v_and_b32 v35, 0xffff0000, v35
    v_sqrt_f32 v35, v35
    s_nop 0
    v_cvt_pk_bf16_f32 v35, v35, v35
    v_and_b32 v35, 0xffff0000, v35
    v_rcp_f32 v35, v35
    v_add_u32 v33, s59, v6
    v_sub_f32 v22, v22, v32
    v_sub_f32 v23, v23, v32
    v_sub_f32 v24, v24, v32
    v_sub_f32 v25, v25, v32
    v_sub_f32 v26, v26, v32
    v_sub_f32 v27, v27, v32
    v_sub_f32 v28, v28, v32
    v_sub_f32 v29, v29, v32
    v_sub_f32 v30, v30, v32
    v_sub_f32 v31, v31, v32
    v_cvt_pk_bf16_f32 v22, v22, v22
    v_and_b32 v22, 0xffff0000, v22
    v_cvt_pk_bf16_f32 v23, v23, v23
    v_and_b32 v23, 0xffff0000, v23
    v_cvt_pk_bf16_f32 v24, v24, v24
    v_and_b32 v24, 0xffff0000, v24
    v_cvt_pk_bf16_f32 v25, v25, v25
    v_and_b32 v25, 0xffff0000, v25
    v_cvt_pk_bf16_f32 v26, v26, v26
    v_and_b32 v26, 0xffff0000, v26
    v_cvt_pk_bf16_f32 v27, v27, v27
    v_and_b32 v27, 0xffff0000, v27
    v_cvt_pk_bf16_f32 v28, v28, v28
    v_and_b32 v28, 0xffff0000, v28
    v_cvt_pk_bf16_f32 v29, v29, v29
    v_and_b32 v29, 0xffff0000, v29
    v_cvt_pk_bf16_f32 v30, v30, v30
    v_and_b32 v30, 0xffff0000, v30
    v_cvt_pk_bf16_f32 v31, v31, v31
    v_and_b32 v31, 0xffff0000, v31
    v_mul_f32 v22, v22, v35
    v_mul_f32 v23, v23, v35
    v_mul_f32 v24, v24, v35
    v_mul_f32 v25, v25, v35
    v_mul_f32 v26, v26, v35
    v_mul_f32 v27, v27, v35
    v_mul_f32 v28, v28, v35
    v_mul_f32 v29, v29, v35
    v_mul_f32 v30, v30, v35
    v_mul_f32 v31, v31, v35
    v_cvt_pk_bf16_f32 v22, v22, v23
    ds_write_b32 v33, v22 offset:0
    v_cvt_pk_bf16_f32 v24, v24, v25
    ds_write_b32 v33, v24 offset:256
    v_cvt_pk_bf16_f32 v26, v26, v27
    ds_write_b32 v33, v26 offset:512
    v_cvt_pk_bf16_f32 v28, v28, v29
    ds_write_b32 v33, v28 offset:768
    v_cvt_pk_bf16_f32 v30, v30, v31
    ds_write_b32 v33, v30 offset:1024
    v_lshrrev_b32 v7, 4, v1
    v_bfe_u32 v8, v1, 2, 2
    v_and_b32 v9, 3, v1
    v_lshl_add_u32 v10, v7, 2, v8
    v_mul_u32_u24 v10, 384, v10
    v_lshl_add_u32 v10, v9, 3, v10
    s_lshl_b32 s58, s3, 6
    v_add_u32 v10, s58, v10
    v_mul_u32_u24 v11, 1280, v8
    v_lshl_add_u32 v11, v7, 3, v11
    s_mul_i32 s58, s57, 160
    v_add_u32 v11, s58, v11
    v_mul_u32_u24 v12, 768, v8
    v_lshl_add_u32 v12, v7, 4, v12
    s_mul_i32 s58, s2, 3072
    s_lshl_b32 s59, s3, 7
    s_add_u32 s58, s58, s59
    s_add_u32 s58, s58, 2097152
    s_lshl_b32 s62, s44, 3
    s_add_u32 s62, s62, s3
    s_mul_i32 s56, s62, 768
    s_add_u32 s56, s56, 196608
    s_mul_i32 s62, s62, 3072
    s_add_u32 s62, s62, 2097152
    s_mul_i32 s59, s45, 768
    s_add_u32 s62, s62, s59
    s_lshl_b32 s45, s44, 7
    s_add_u32 s45, s45, 32768
    v_min_u32 v13, 47, v1
    v_lshlrev_b32 v13, 4, v13
    s_mul_i32 s59, s3, 768
    v_add_u32 v14, s59, v13
    s_waitcnt vmcnt(12) lgkmcnt(0)
    s_mul_i32 s52, s52, 1664525
    s_add_u32 s52, s52, 1013904223
    s_barrier
    s_cmp_ge_u32 s3, 6
    s_cbranch_scc1 L_noq
    ds_read_b64 v[60:61], v11 offset:0
    ds_read_b64_tr_b16 v[40:41], v10 offset:36864
    ds_read_b64_tr_b16 v[42:43], v10 offset:36896
    ds_read_b64 v[62:63], v11 offset:32
    ds_read_b64_tr_b16 v[44:45], v10 offset:43008
    ds_read_b64_tr_b16 v[46:47], v10 offset:43040
    ds_read_b64 v[64:65], v11 offset:64
    ds_read_b64_tr_b16 v[48:49], v10 offset:49152
    ds_read_b64_tr_b16 v[50:51], v10 offset:49184
    ds_read_b64 v[66:67], v11 offset:96
    ds_read_b64_tr_b16 v[52:53], v10 offset:55296
    ds_read_b64_tr_b16 v[54:55], v10 offset:55328
    ds_read_b64 v[68:69], v11 offset:128
    ds_read_b64_tr_b16 v[56:57], v10 offset:61440
    ds_read_b64_tr_b16 v[58:59], v10 offset:61472
    v_mov_b32 v16, 0
    v_mov_b32 v17, 0
    v_mov_b32 v18, 0
    v_mov_b32 v19, 0
    v_mov_b32 v20, 0
    v_mov_b32 v21, 0
    v_mov_b32 v22, 0
    v_mov_b32 v23, 0
    s_waitcnt lgkmcnt(12)
    v_mfma_f32_16x16x16_bf16 v[16:19], v[40:41], v[60:61], v[16:19]
    v_mfma_f32_16x16x16_bf16 v[20:23], v[42:43], v[60:61], v[20:23]
    s_waitcnt lgkmcnt(9)
    v_mfma_f32_16x16x16_bf16 v[16:19], v[44:45], v[62:63], v[16:19]
    v_mfma_f32_16x16x16_bf16 v[20:23], v[46:47], v[62:63], v[20:23]
    s_waitcnt lgkmcnt(6)
    v_mfma_f32_16x16x16_bf16 v[16:19], v[48:49], v[64:65], v[16:19]
    v_mfma_f32_16x16x16_bf16 v[20:23], v[50:51], v[64:65], v[20:23]
    s_waitcnt lgkmcnt(3)
    v_mfma_f32_16x16x16_bf16 v[16:19], v[52:53], v[66:67], v[16:19]
    v_mfma_f32_16x16x16_bf16 v[20:23], v[54:55], v[66:67], v[20:23]
    s_waitcnt lgkmcnt(0)
    v_mfma_f32_16x16x16_bf16 v[16:19], v[56:57], v[68:69], v[16:19]
    v_mfma_f32_16x16x16_bf16 v[20:23], v[58:59], v[68:69], v[20:23]
    s_mov_b32 exec_lo, 0x11111111
    s_mov_b32 exec_hi, 0x11111111
    s_nop 4
    buffer_store_dwordx4 v[16:19], v12, s[24:27], s58 offen offset:0 sc1
    buffer_store_dwordx4 v[20:23], v12, s[24:27], s58 offen offset:64 sc1
    s_mov_b64 exec, -1
L_noq:
    s_nop 4
    buffer_load_dwordx4 v[160:163], v4, s[4:7], s48 offen offset:0 nt
    buffer_load_dwordx4 v[164:167], v4, s[4:7], s48 offen offset:128 nt
    buffer_load_dwordx4 v[168:171], v4, s[4:7], s48 offen offset:256 nt
    s_add_u32 s48, s48, 3072
    s_waitcnt vmcnt(3)
    s_cmp_ge_u32 s3, 6
    s_cbranch_scc1 L_noflag
    v_mov_b32 v7, 9740
    v_mov_b32 v8, 1
    s_mov_b64 exec, 1
    ds_add_rtn_u32 v9, v7, v8
    s_waitcnt lgkmcnt(0)
    v_readfirstlane_b32 s58, v9
    s_nop 1
    s_cmp_lg_u32 s58, 5
    s_cbranch_scc1 L_noflag
    s_lshl_b32 s58, s57, 2
    v_mov_b32 v7, s58
    v_mov_b32 v8, s52
    buffer_store_dword v8, v7, s[24:27], s45 offen sc1
L_noflag:
    s_nop 4
    s_mov_b64 exec, -1
    s_lshl_b32 s50, s47, 7
    s_add_u32 s50, s50, 16384
    s_cmp_lg_u32 s40, 7
    s_cbranch_scc1 L_noinit
    v_mov_b32 v8, 32
    v_mov_b32 v9, s52
    v_mov_b32 v7, 0
    s_mov_b64 exec, 1
    buffer_store_dwordx2 v[8:9], v7, s[24:27], s50 offen sc1
    s_mov_b64 exec, -1
L_noinit:
    s_nop 4
    s_add_u32 s42, s42, 0
    s_lshl_b32 s41, s47, 13
    s_add_u32 s41, s41, 2883584
    s_movk_i32 s64, 96
    s_cmp_lt_u32 s46, 3
    s_cselect_b32 s64, 68, s64
    s_xor_b32 s58, s57, 1
    s_add_u32 s58, s58, s44
    s_and_b32 s58, s58, 7
    s_cmp_lt_u32 s58, 0
    s_cselect_b32 s64, 96, s64
    s_lshl_b32 s65, s47, 8
    s_add_u32 s65, s65, 40960
    s_cmp_lt_u32 s46, 3
    s_cbranch_scc1 L_nowo
    s_mul_i32 s58, s3, 24
    s_mul_i32 s55, s44, 192
    s_add_u32 s55, s55, s58
    s_mul_i32 s55, s55, 1280
    s_lshl_b32 s58, s46, 8
    s_add_u32 s55, s55, s58
    s_sub_u32 s55, s55, 768
    s_mul_i32 s59, s3, 6144
    s_add_u32 s59, s59, 69632
    v_lshrrev_b32 v7, 4, v1
    v_mul_u32_u24 v7, 1280, v7
    v_and_b32 v8, 15, v1
    v_lshl_add_u32 v7, v8, 4, v7
    s_mov_b32 m0, s59
    s_nop 0
    buffer_load_dwordx4 v7, s[16:19], s55 offen nt lds
    s_add_u32 s59, s59, 1024
    s_add_u32 s55, s55, 5120
    s_mov_b32 m0, s59
    s_nop 0
    buffer_load_dwordx4 v7, s[16:19], s55 offen nt lds
    s_add_u32 s59, s59, 1024
    s_add_u32 s55, s55, 5120
    s_mov_b32 m0, s59
    s_nop 0
    buffer_load_dwordx4 v7, s[16:19], s55 offen nt lds
    s_add_u32 s59, s59, 1024
    s_add_u32 s55, s55, 5120
    s_mov_b32 m0, s59
    s_nop 0
    buffer_load_dwordx4 v7, s[16:19], s55 offen nt lds
    s_add_u32 s59, s59, 1024
    s_add_u32 s55, s55, 5120
    s_mov_b32 m0, s59
    s_nop 0
    buffer_load_dwordx4 v7, s[16:19], s55 offen nt lds
    s_add_u32 s59, s59, 1024
    s_add_u32 s55, s55, 5120
    s_mov_b32 m0, s59
    s_nop 0
    buffer_load_dwordx4 v7, s[16:19], s55 offen nt lds
L_nowo:
    s_nop 4
    s_mov_b32 s63, 0
    s_lshl_b32 s58, s3, 2
    v_mov_b32 v109, s58
    v_not_b32 v108, s52
    s_waitcnt vmcnt(1)
    buffer_load_dwordx4 v[172:175], v4, s[4:7], s48 offen offset:0 nt
    buffer_load_dwordx4 v[176:179], v4, s[4:7], s48 offen offset:128 nt
    buffer_load_dwordx4 v[180:183], v4, s[4:7], s48 offen offset:256 nt
    s_add_u32 s48, s48, 3072
    s_waitcnt vmcnt(1)
    s_cmp_eq_u32 s63, 2
    s_cbranch_scc1 L_qs6
    s_cmp_eq_u32 s63, 0
    s_cbranch_scc1 L_qf6
    ds_write_b128 v14, v[16:19] offset:12288
    s_mov_b32 s63, 2
    v_mov_b32 v7, 9732
    v_mov_b32 v8, 1
    s_waitcnt lgkmcnt(0)
    s_mov_b64 exec, 1
    ds_add_rtn_u32 v9, v7, v8
    s_waitcnt lgkmcnt(0)
    s_mov_b64 exec, -1
    v_readfirstlane_b32 s58, v9
    s_nop 1
    s_cmp_lg_u32 s58, 7
    s_cbranch_scc1 L_qa1
    s_call_b64 s[92:93], L_qsum
L_qa1:
    s_nop 4
    s_branch L_qs6
L_qf6:
    s_nop 4
    v_readfirstlane_b32 s58, v108
    s_nop 1
    s_cmp_eq_u32 s58, s52
    s_cbranch_scc0 L_qr6
    buffer_load_dwordx4 v[16:19], v13, s[24:27], s62 offen sc1
    s_mov_b32 s63, 1
    s_branch L_qs6
L_qr6:
    s_nop 4
    buffer_load_dword v108, v109, s[24:27], s45 offen sc1
L_qs6:
    s_nop 4
    buffer_load_dwordx4 v[184:187], v4, s[4:7], s48 offen offset:0 nt
    buffer_load_dwordx4 v[188:191], v4, s[4:7], s48 offen offset:128 nt
    buffer_load_dwordx4 v[192:195], v4, s[4:7], s48 offen offset:256 nt
    s_add_u32 s48, s48, 3072
    s_waitcnt vmcnt(1)
    s_cmp_eq_u32 s63, 2
    s_cbranch_scc1 L_qs7
    s_cmp_eq_u32 s63, 0
    s_cbranch_scc1 L_qf7
    ds_write_b128 v14, v[16:19] offset:12288
    s_mov_b32 s63, 2
    v_mov_b32 v7, 9732
    v_mov_b32 v8, 1
    s_waitcnt lgkmcnt(0)
    s_mov_b64 exec, 1
    ds_add_rtn_u32 v9, v7, v8
    s_waitcnt lgkmcnt(0)
    s_mov_b64 exec, -1
    v_readfirstlane_b32 s58, v9
    s_nop 1
    s_cmp_lg_u32 s58, 7
    s_cbranch_scc1 L_qa2
    s_call_b64 s[92:93], L_qsum
L_qa2:
    s_nop 4
    s_branch L_qs7
L_qf7:
    s_nop 4
    v_readfirstlane_b32 s58, v108
    s_nop 1
    s_cmp_eq_u32 s58, s52
    s_cbranch_scc0 L_qr7
    buffer_load_dwordx4 v[16:19], v13, s[24:27], s62 offen sc1
    s_mov_b32 s63, 1
    s_branch L_qs7
L_qr7:
    s_nop 4
    buffer_load_dword v108, v109, s[24:27], s45 offen sc1
L_qs7:
    s_nop 4
    buffer_load_dwordx4 v[196:199], v4, s[4:7], s48 offen offset:0 nt
    buffer_load_dwordx4 v[200:203], v4, s[4:7], s48 offen offset:128 nt
    buffer_load_dwordx4 v[204:207], v4, s[4:7], s48 offen offset:256 nt
    s_add_u32 s48, s48, 3072
    s_waitcnt vmcnt(1)
    s_cmp_eq_u32 s63, 2
    s_cbranch_scc1 L_qs8
    s_cmp_eq_u32 s63, 0
    s_cbranch_scc1 L_qf8
    ds_write_b128 v14, v[16:19] offset:12288
    s_mov_b32 s63, 2
    v_mov_b32 v7, 9732
    v_mov_b32 v8, 1
    s_waitcnt lgkmcnt(0)
    s_mov_b64 exec, 1
    ds_add_rtn_u32 v9, v7, v8
    s_waitcnt lgkmcnt(0)
    s_mov_b64 exec, -1
    v_readfirstlane_b32 s58, v9
    s_nop 1
    s_cmp_lg_u32 s58, 7
    s_cbranch_scc1 L_qa3
    s_call_b64 s[92:93], L_qsum
L_qa3:
    s_nop 4
    s_branch L_qs8
L_qf8:
    s_nop 4
    v_readfirstlane_b32 s58, v108
    s_nop 1
    s_cmp_eq_u32 s58, s52
    s_cbranch_scc0 L_qr8
    buffer_load_dwordx4 v[16:19], v13, s[24:27], s62 offen sc1
    s_mov_b32 s63, 1
    s_branch L_qs8
L_qr8:
    s_nop 4
    buffer_load_dword v108, v109, s[24:27], s45 offen sc1
L_qs8:
    s_nop 4
    s_add_u32 s48, s99, 1
    s_and_b32 s48, s48, 3
    s_mul_i32 s48, s48, 196608
    s_add_u32 s48, s48, s49
    buffer_load_dwordx4 v[208:211], v4, s[4:7], s48 offen offset:0 nt
    buffer_load_dwordx4 v[212:215], v4, s[4:7], s48 offen offset:128 nt
    buffer_load_dwordx4 v[216:219], v4, s[4:7], s48 offen offset:256 nt
    s_add_u32 s48, s48, 3072
    s_waitcnt vmcnt(1)
    s_cmp_eq_u32 s63, 2
    s_cbranch_scc1 L_qs9
    s_cmp_eq_u32 s63, 0
    s_cbranch_scc1 L_qf9
    ds_write_b128 v14, v[16:19] offset:12288
    s_mov_b32 s63, 2
    v_mov_b32 v7, 9732
    v_mov_b32 v8, 1
    s_waitcnt lgkmcnt(0)
    s_mov_b64 exec, 1
    ds_add_rtn_u32 v9, v7, v8
    s_waitcnt lgkmcnt(0)
    s_mov_b64 exec, -1
    v_readfirstlane_b32 s58, v9
    s_nop 1
    s_cmp_lg_u32 s58, 7
    s_cbranch_scc1 L_qa4
    s_call_b64 s[92:93], L_qsum
L_qa4:
    s_nop 4
    s_branch L_qs9
L_qf9:
    s_nop 4
    v_readfirstlane_b32 s58, v108
    s_nop 1
    s_cmp_eq_u32 s58, s52
    s_cbranch_scc0 L_qr9
    buffer_load_dwordx4 v[16:19], v13, s[24:27], s62 offen sc1
    s_mov_b32 s63, 1
    s_branch L_qs9
L_qr9:
    s_nop 4
    buffer_load_dword v108, v109, s[24:27], s45 offen sc1
L_qs9:
    s_nop 4
    buffer_load_dwordx4 v[224:227], v4, s[4:7], s48 offen offset:0 nt
    buffer_load_dwordx4 v[228:231], v4, s[4:7], s48 offen offset:128 nt
    buffer_load_dwordx4 v[232:235], v4, s[4:7], s48 offen offset:256 nt
    s_add_u32 s48, s48, 3072
    s_waitcnt vmcnt(1)
    s_cmp_eq_u32 s63, 2
    s_cbranch_scc1 L_qs10
    s_cmp_eq_u32 s63, 0
    s_cbranch_scc1 L_qf10
    ds_write_b128 v14, v[16:19] offset:12288
    s_mov_b32 s63, 2
    v_mov_b32 v7, 9732
    v_mov_b32 v8, 1
    s_waitcnt lgkmcnt(0)
    s_mov_b64 exec, 1
    ds_add_rtn_u32 v9, v7, v8
    s_waitcnt lgkmcnt(0)
    s_mov_b64 exec, -1
    v_readfirstlane_b32 s58, v9
    s_nop 1
    s_cmp_lg_u32 s58, 7
    s_cbranch_scc1 L_qa5
    s_call_b64 s[92:93], L_qsum
L_qa5:
    s_nop 4
    s_branch L_qs10
L_qf10:
    s_nop 4
    v_readfirstlane_b32 s58, v108
    s_nop 1
    s_cmp_eq_u32 s58, s52
    s_cbranch_scc0 L_qr10
    buffer_load_dwordx4 v[16:19], v13, s[24:27], s62 offen sc1
    s_mov_b32 s63, 1
    s_branch L_qs10
L_qr10:
    s_nop 4
    buffer_load_dword v108, v109, s[24:27], s45 offen sc1
L_qs10:
    s_nop 4
    buffer_load_dwordx4 v[236:239], v4, s[4:7], s48 offen offset:0 nt
    buffer_load_dwordx4 v[240:243], v4, s[4:7], s48 offen offset:128 nt
    buffer_load_dwordx4 v[244:247], v4, s[4:7], s48 offen offset:256 nt
    s_add_u32 s48, s48, 3072
    s_cmp_eq_u32 s63, 2
    s_cbranch_scc1 L_qdone
    s_cmp_eq_u32 s63, 1
    s_cbranch_scc1 L_qg2
    s_mov_b32 s43, 60000
L_qspin_re:
    s_nop 4
    s_mov_b32 s60, 32
L_qspin:
    s_nop 4
    buffer_load_dword v108, v109, s[24:27], s45 offen sc1
    s_waitcnt vmcnt(0)
    v_cmp_ne_u32 vcc, s52, v108
    s_nop 4
    s_cbranch_vccz L_qspin_done
    s_sleep 1
    s_sub_u32 s60, s60, 1
    s_cmp_lg_u32 s60, 0
    s_cbranch_scc1 L_qspin
    s_branch L_qspin_slow
L_qspin_done:
    s_nop 4
    buffer_load_dwordx4 v[16:19], v13, s[24:27], s62 offen sc1
L_qg2:
    s_nop 4
    s_waitcnt vmcnt(0)
    ds_write_b128 v14, v[16:19] offset:12288
    s_mov_b32 s63, 2
    v_mov_b32 v7, 9732
    v_mov_b32 v8, 1
    s_waitcnt lgkmcnt(0)
    s_mov_b64 exec, 1
    ds_add_rtn_u32 v9, v7, v8
    s_waitcnt lgkmcnt(0)
    s_mov_b64 exec, -1
    v_readfirstlane_b32 s58, v9
    s_nop 1
    s_cmp_lg_u32 s58, 7
    s_cbranch_scc1 L_qa6
    s_call_b64 s[92:93], L_qsum
L_qa6:
    s_nop 4
L_qdone:
    s_nop 4
    v_mov_b32 v7, 9736
L_qrdy:
    s_nop 4
    ds_read_b32 v8, v7
    s_waitcnt lgkmcnt(0)
    v_readfirstlane_b32 s58, v8
    s_nop 1
    s_cmp_ge_u32 s58, 1
    s_cbranch_scc1 L_qrdy_ok
    s_sleep 1
    s_branch L_qrdy
L_qrdy_ok:
    s_nop 4
    s_mov_b32 s54, 0x3d93cd3a
    s_mov_b32 s53, 0x3fb8aa3b
    v_lshlrev_b32 v99, 4, v3
    ds_read_b128 v[40:43], v99 offset:5120
    ds_read_b128 v[44:47], v99 offset:5248
    ds_read_b128 v[48:51], v99 offset:5376
    s_mul_i32 s59, s3, 768
    v_mul_u32_u24 v7, 3, v2
    v_add_u32 v7, 0, v7
    v_lshrrev_b32 v8, 3, v7
    v_and_b32 v7, 7, v7
    v_lshl_add_u32 v7, v8, 6, v7
    v_lshl_add_u32 v7, v3, 3, v7
    v_lshlrev_b32 v7, 2, v7
    v_add_u32 v96, s59, v7
    v_mul_u32_u24 v7, 3, v2
    v_add_u32 v7, 1, v7
    v_lshrrev_b32 v8, 3, v7
    v_and_b32 v7, 7, v7
    v_lshl_add_u32 v7, v8, 6, v7
    v_lshl_add_u32 v7, v3, 3, v7
    v_lshlrev_b32 v7, 2, v7
    v_add_u32 v97, s59, v7
    v_mul_u32_u24 v7, 3, v2
    v_add_u32 v7, 2, v7
    v_lshrrev_b32 v8, 3, v7
    v_and_b32 v7, 7, v7
    v_lshl_add_u32 v7, v8, 6, v7
    v_lshl_add_u32 v7, v3, 3, v7
    v_lshlrev_b32 v7, 2, v7
    v_add_u32 v98, s59, v7
    v_bfe_u32 v8, v1, 2, 2
    v_lshrrev_b32 v9, 4, v1
    v_mul_u32_u24 v7, 384, v8
    v_lshl_add_u32 v100, v9, 4, v7
    v_lshlrev_b32 v7, 9, v8
    v_lshl_add_u32 v101, v9, 4, v7
    v_min_u32 v7, 383, v0
    v_lshlrev_b32 v102, 3, v7
    v_mul_u32_u24 v7, 0xaaab, v7
    v_lshrrev_b32 v7, 22, v7
    v_lshlrev_b32 v103, 6, v7
    s_lshl_b32 s62, s46, 5
    s_add_u32 s62, s62, s44
    s_lshl_b32 s62, s62, 11
    s_lshl_b32 s59, s3, 6
    s_add_u32 s62, s62, s59
    s_add_u32 s62, s62, 196608
    s_mul_i32 s55, s2, 768
    s_add_u32 s55, s55, 196608
    s_lshl_b32 s63, s3, 3
    v_mov_b32 v88, 0
    v_lshlrev_b32 v89, 3, v2
    v_lshl_add_u32 v90, v3, 10, v89
    s_and_b32 s58, s3, 1
    s_mul_i32 s58, s58, 1536
    s_lshr_b32 s59, s3, 1
    s_mul_i32 s59, s59, 384
    s_add_u32 s58, s58, s59
    s_add_u32 s58, s58, 6656
    v_lshrrev_b32 v7, 1, v13
    v_add_u32 v102, s58, v7
    v_and_b32 v7, 15, v1
    v_lshlrev_b32 v103, 4, v7
    v_mov_b32 v95, s52
    s_waitcnt lgkmcnt(0)
    s_waitcnt vmcnt(28)
    v_mov_b32 v52, 0
    v_dot2c_f32_bf16 v52, v112, v40
    v_dot2c_f32_bf16 v52, v113, v41
    v_dot2c_f32_bf16 v52, v114, v42
    v_dot2c_f32_bf16 v52, v115, v43
    v_dot2c_f32_bf16 v52, v116, v44
    v_dot2c_f32_bf16 v52, v117, v45
    v_dot2c_f32_bf16 v52, v118, v46
    v_dot2c_f32_bf16 v52, v119, v47
    v_dot2c_f32_bf16 v52, v120, v48
    v_dot2c_f32_bf16 v52, v121, v49
    v_dot2c_f32_bf16 v52, v122, v50
    v_dot2c_f32_bf16 v52, v123, v51
    buffer_load_dwordx4 v[112:115], v4, s[4:7], s48 offen offset:0 nt
    buffer_load_dwordx4 v[116:119], v4, s[4:7], s48 offen offset:128 nt
    buffer_load_dwordx4 v[120:123], v4, s[4:7], s48 offen offset:256 nt
    s_add_u32 s48, s48, 3072
    v_add_f32_dpp v52, v52, v52 quad_perm:[1,0,3,2] row_mask:0xf bank_mask:0xf
    s_nop 1
    v_add_f32_dpp v52, v52, v52 quad_perm:[2,3,0,1] row_mask:0xf bank_mask:0xf
    s_nop 1
    v_add_f32_dpp v52, v52, v52 row_half_mirror row_mask:0xf bank_mask:0xf
    v_cvt_pk_bf16_f32 v52, v52, v52
    v_and_b32 v52, 0xffff0000, v52
    v_mul_f32 v52, s54, v52
    v_cvt_pk_bf16_f32 v52, v52, v52
    v_and_b32 v52, 0xffff0000, v52
    s_waitcnt vmcnt(28)
    v_mov_b32 v53, 0
    v_dot2c_f32_bf16 v53, v124, v40
    v_dot2c_f32_bf16 v53, v125, v41
    v_dot2c_f32_bf16 v53, v126, v42
    v_dot2c_f32_bf16 v53, v127, v43
    v_dot2c_f32_bf16 v53, v128, v44
    v_dot2c_f32_bf16 v53, v129, v45
    v_dot2c_f32_bf16 v53, v130, v46
    v_dot2c_f32_bf16 v53, v131, v47
    v_dot2c_f32_bf16 v53, v132, v48
    v_dot2c_f32_bf16 v53, v133, v49
    v_dot2c_f32_bf16 v53, v134, v50
    v_dot2c_f32_bf16 v53, v135, v51
    buffer_load_dwordx4 v[124:127], v4, s[4:7], s48 offen offset:0 nt
    buffer_load_dwordx4 v[128:131], v4, s[4:7], s48 offen offset:128 nt
    buffer_load_dwordx4 v[132:135], v4, s[4:7], s48 offen offset:256 nt
    s_add_u32 s48, s48, 3072
    v_add_f32_dpp v53, v53, v53 quad_perm:[1,0,3,2] row_mask:0xf bank_mask:0xf
    s_nop 1
    v_add_f32_dpp v53, v53, v53 quad_perm:[2,3,0,1] row_mask:0xf bank_mask:0xf
    s_nop 1
    v_add_f32_dpp v53, v53, v53 row_half_mirror row_mask:0xf bank_mask:0xf
    v_cvt_pk_bf16_f32 v53, v53, v53
    v_and_b32 v53, 0xffff0000, v53
    v_mul_f32 v53, s54, v53
    v_cvt_pk_bf16_f32 v53, v53, v53
    v_and_b32 v53, 0xffff0000, v53
    s_waitcnt vmcnt(28)
    v_mov_b32 v54, 0
    v_dot2c_f32_bf16 v54, v136, v40
    v_dot2c_f32_bf16 v54, v137, v41
    v_dot2c_f32_bf16 v54, v138, v42
    v_dot2c_f32_bf16 v54, v139, v43
    v_dot2c_f32_bf16 v54, v140, v44
    v_dot2c_f32_bf16 v54, v141, v45
    v_dot2c_f32_bf16 v54, v142, v46
    v_dot2c_f32_bf16 v54, v143, v47
    v_dot2c_f32_bf16 v54, v144, v48
    v_dot2c_f32_bf16 v54, v145, v49
    v_dot2c_f32_bf16 v54, v146, v50
    v_dot2c_f32_bf16 v54, v147, v51
    s_nop 2
    v_add_f32_dpp v54, v54, v54 quad_perm:[1,0,3,2] row_mask:0xf bank_mask:0xf
    s_nop 1
    v_add_f32_dpp v54, v54, v54 quad_perm:[2,3,0,1] row_mask:0xf bank_mask:0xf
    s_nop 1
    v_add_f32_dpp v54, v54, v54 row_half_mirror row_mask:0xf bank_mask:0xf
    v_cvt_pk_bf16_f32 v54, v54, v54
    v_and_b32 v54, 0xffff0000, v54
    v_mul_f32 v54, s54, v54
    v_cvt_pk_bf16_f32 v54, v54, v54
    v_and_b32 v54, 0xffff0000, v54
    s_waitcnt vmcnt(25)
    v_mov_b32 v55, 0
    v_dot2c_f32_bf16 v55, v148, v40
    v_dot2c_f32_bf16 v55, v149, v41
    v_dot2c_f32_bf16 v55, v150, v42
    v_dot2c_f32_bf16 v55, v151, v43
    v_dot2c_f32_bf16 v55, v152, v44
    v_dot2c_f32_bf16 v55, v153, v45
    v_dot2c_f32_bf16 v55, v154, v46
    v_dot2c_f32_bf16 v55, v155, v47
    v_dot2c_f32_bf16 v55, v156, v48
    v_dot2c_f32_bf16 v55, v157, v49
    v_dot2c_f32_bf16 v55, v158, v50
    v_dot2c_f32_bf16 v55, v159, v51
    s_nop 2
    v_add_f32_dpp v55, v55, v55 quad_perm:[1,0,3,2] row_mask:0xf bank_mask:0xf
    s_nop 1
    v_add_f32_dpp v55, v55, v55 quad_perm:[2,3,0,1] row_mask:0xf bank_mask:0xf
    s_nop 1
    v_add_f32_dpp v55, v55, v55 row_half_mirror row_mask:0xf bank_mask:0xf
    v_cvt_pk_bf16_f32 v55, v55, v55
    v_and_b32 v55, 0xffff0000, v55
    v_mul_f32 v55, s54, v55
    v_cvt_pk_bf16_f32 v55, v55, v55
    v_and_b32 v55, 0xffff0000, v55
    s_waitcnt vmcnt(22)
    v_mov_b32 v56, 0
    v_dot2c_f32_bf16 v56, v160, v40
    v_dot2c_f32_bf16 v56, v161, v41
    v_dot2c_f32_bf16 v56, v162, v42
    v_dot2c_f32_bf16 v56, v163, v43
    v_dot2c_f32_bf16 v56, v164, v44
    v_dot2c_f32_bf16 v56, v165, v45
    v_dot2c_f32_bf16 v56, v166, v46
    v_dot2c_f32_bf16 v56, v167, v47
    v_dot2c_f32_bf16 v56, v168, v48
    v_dot2c_f32_bf16 v56, v169, v49
    v_dot2c_f32_bf16 v56, v170, v50
    v_dot2c_f32_bf16 v56, v171, v51
    s_nop 2
    v_add_f32_dpp v56, v56, v56 quad_perm:[1,0,3,2] row_mask:0xf bank_mask:0xf
    s_nop 1
    v_add_f32_dpp v56, v56, v56 quad_perm:[2,3,0,1] row_mask:0xf bank_mask:0xf
    s_nop 1
    v_add_f32_dpp v56, v56, v56 row_half_mirror row_mask:0xf bank_mask:0xf
    v_cvt_pk_bf16_f32 v56, v56, v56
    v_and_b32 v56, 0xffff0000, v56
    v_mul_f32 v56, s54, v56
    v_cvt_pk_bf16_f32 v56, v56, v56
    v_and_b32 v56, 0xffff0000, v56
    s_waitcnt vmcnt(19)
    v_mov_b32 v57, 0
    v_dot2c_f32_bf16 v57, v172, v40
    v_dot2c_f32_bf16 v57, v173, v41
    v_dot2c_f32_bf16 v57, v174, v42
    v_dot2c_f32_bf16 v57, v175, v43
    v_dot2c_f32_bf16 v57, v176, v44
    v_dot2c_f32_bf16 v57, v177, v45
    v_dot2c_f32_bf16 v57, v178, v46
    v_dot2c_f32_bf16 v57, v179, v47
    v_dot2c_f32_bf16 v57, v180, v48
    v_dot2c_f32_bf16 v57, v181, v49
    v_dot2c_f32_bf16 v57, v182, v50
    v_dot2c_f32_bf16 v57, v183, v51
    s_nop 2
    v_add_f32_dpp v57, v57, v57 quad_perm:[1,0,3,2] row_mask:0xf bank_mask:0xf
    s_nop 1
    v_add_f32_dpp v57, v57, v57 quad_perm:[2,3,0,1] row_mask:0xf bank_mask:0xf
    s_nop 1
    v_add_f32_dpp v57, v57, v57 row_half_mirror row_mask:0xf bank_mask:0xf
    v_cvt_pk_bf16_f32 v57, v57, v57
    v_and_b32 v57, 0xffff0000, v57
    v_mul_f32 v57, s54, v57
    v_cvt_pk_bf16_f32 v57, v57, v57
    v_and_b32 v57, 0xffff0000, v57
    s_waitcnt vmcnt(16)
    v_mov_b32 v58, 0
    v_dot2c_f32_bf16 v58, v184, v40
    v_dot2c_f32_bf16 v58, v185, v41
    v_dot2c_f32_bf16 v58, v186, v42
    v_dot2c_f32_bf16 v58, v187, v43
    v_dot2c_f32_bf16 v58, v188, v44
    v_dot2c_f32_bf16 v58, v189, v45
    v_dot2c_f32_bf16 v58, v190, v46
    v_dot2c_f32_bf16 v58, v191, v47
    v_dot2c_f32_bf16 v58, v192, v48
    v_dot2c_f32_bf16 v58, v193, v49
    v_dot2c_f32_bf16 v58, v194, v50
    v_dot2c_f32_bf16 v58, v195, v51
    s_nop 2
    v_add_f32_dpp v58, v58, v58 quad_perm:[1,0,3,2] row_mask:0xf bank_mask:0xf
    s_nop 1
    v_add_f32_dpp v58, v58, v58 quad_perm:[2,3,0,1] row_mask:0xf bank_mask:0xf
    s_nop 1
    v_add_f32_dpp v58, v58, v58 row_half_mirror row_mask:0xf bank_mask:0xf
    v_cvt_pk_bf16_f32 v58, v58, v58
    v_and_b32 v58, 0xffff0000, v58
    v_mul_f32 v58, s54, v58
    v_cvt_pk_bf16_f32 v58, v58, v58
    v_and_b32 v58, 0xffff0000, v58
    s_waitcnt vmcnt(13)
    v_mov_b32 v59, 0
    v_dot2c_f32_bf16 v59, v196, v40
    v_dot2c_f32_bf16 v59, v197, v41
    v_dot2c_f32_bf16 v59, v198, v42
    v_dot2c_f32_bf16 v59, v199, v43
    v_dot2c_f32_bf16 v59, v200, v44
    v_dot2c_f32_bf16 v59, v201, v45
    v_dot2c_f32_bf16 v59, v202, v46
    v_dot2c_f32_bf16 v59, v203, v47
    v_dot2c_f32_bf16 v59, v204, v48
    v_dot2c_f32_bf16 v59, v205, v49
    v_dot2c_f32_bf16 v59, v206, v50
    v_dot2c_f32_bf16 v59, v207, v51
    s_nop 2
    v_add_f32_dpp v59, v59, v59 quad_perm:[1,0,3,2] row_mask:0xf bank_mask:0xf
    s_nop 1
    v_add_f32_dpp v59, v59, v59 quad_perm:[2,3,0,1] row_mask:0xf bank_mask:0xf
    s_nop 1
    v_add_f32_dpp v59, v59, v59 row_half_mirror row_mask:0xf bank_mask:0xf
    v_cvt_pk_bf16_f32 v59, v59, v59
    v_and_b32 v59, 0xffff0000, v59
    v_mul_f32 v59, s54, v59
    v_cvt_pk_bf16_f32 v59, v59, v59
    v_and_b32 v59, 0xffff0000, v59
    s_waitcnt vmcnt(10)
    v_mov_b32 v60, 0
    v_dot2c_f32_bf16 v60, v208, v40
    v_dot2c_f32_bf16 v60, v209, v41
    v_dot2c_f32_bf16 v60, v210, v42
    v_dot2c_f32_bf16 v60, v211, v43
    v_dot2c_f32_bf16 v60, v212, v44
    v_dot2c_f32_bf16 v60, v213, v45
    v_dot2c_f32_bf16 v60, v214, v46
    v_dot2c_f32_bf16 v60, v215, v47
    v_dot2c_f32_bf16 v60, v216, v48
    v_dot2c_f32_bf16 v60, v217, v49
    v_dot2c_f32_bf16 v60, v218, v50
    v_dot2c_f32_bf16 v60, v219, v51
    s_nop 2
    v_add_f32_dpp v60, v60, v60 quad_perm:[1,0,3,2] row_mask:0xf bank_mask:0xf
    s_nop 1
    v_add_f32_dpp v60, v60, v60 quad_perm:[2,3,0,1] row_mask:0xf bank_mask:0xf
    s_nop 1
    v_add_f32_dpp v60, v60, v60 row_half_mirror row_mask:0xf bank_mask:0xf
    v_cvt_pk_bf16_f32 v60, v60, v60
    v_and_b32 v60, 0xffff0000, v60
    v_mul_f32 v60, s54, v60
    v_cvt_pk_bf16_f32 v60, v60, v60
    v_and_b32 v60, 0xffff0000, v60
    s_waitcnt vmcnt(7)
    v_mov_b32 v61, 0
    v_dot2c_f32_bf16 v61, v224, v40
    v_dot2c_f32_bf16 v61, v225, v41
    v_dot2c_f32_bf16 v61, v226, v42
    v_dot2c_f32_bf16 v61, v227, v43
    v_dot2c_f32_bf16 v61, v228, v44
    v_dot2c_f32_bf16 v61, v229, v45
    v_dot2c_f32_bf16 v61, v230, v46
    v_dot2c_f32_bf16 v61, v231, v47
    v_dot2c_f32_bf16 v61, v232, v48
    v_dot2c_f32_bf16 v61, v233, v49
    v_dot2c_f32_bf16 v61, v234, v50
    v_dot2c_f32_bf16 v61, v235, v51
    s_nop 2
    v_add_f32_dpp v61, v61, v61 quad_perm:[1,0,3,2] row_mask:0xf bank_mask:0xf
    s_nop 1
    v_add_f32_dpp v61, v61, v61 quad_perm:[2,3,0,1] row_mask:0xf bank_mask:0xf
    s_nop 1
    v_add_f32_dpp v61, v61, v61 row_half_mirror row_mask:0xf bank_mask:0xf
    v_cvt_pk_bf16_f32 v61, v61, v61
    v_and_b32 v61, 0xffff0000, v61
    v_mul_f32 v61, s54, v61
    v_cvt_pk_bf16_f32 v61, v61, v61
    v_and_b32 v61, 0xffff0000, v61
    s_waitcnt vmcnt(4)
    v_mov_b32 v62, 0
    v_dot2c_f32_bf16 v62, v236, v40
    v_dot2c_f32_bf16 v62, v237, v41
    v_dot2c_f32_bf16 v62, v238, v42
    v_dot2c_f32_bf16 v62, v239, v43
    v_dot2c_f32_bf16 v62, v240, v44
    v_dot2c_f32_bf16 v62, v241, v45
    v_dot2c_f32_bf16 v62, v242, v46
    v_dot2c_f32_bf16 v62, v243, v47
    v_dot2c_f32_bf16 v62, v244, v48
    v_dot2c_f32_bf16 v62, v245, v49
    v_dot2c_f32_bf16 v62, v246, v50
    v_dot2c_f32_bf16 v62, v247, v51
    s_nop 2
    v_add_f32_dpp v62, v62, v62 quad_perm:[1,0,3,2] row_mask:0xf bank_mask:0xf
    s_nop 1
    v_add_f32_dpp v62, v62, v62 quad_perm:[2,3,0,1] row_mask:0xf bank_mask:0xf
    s_nop 1
    v_add_f32_dpp v62, v62, v62 row_half_mirror row_mask:0xf bank_mask:0xf
    v_cvt_pk_bf16_f32 v62, v62, v62
    v_and_b32 v62, 0xffff0000, v62
    v_mul_f32 v62, s54, v62
    v_cvt_pk_bf16_f32 v62, v62, v62
    v_and_b32 v62, 0xffff0000, v62
    s_waitcnt vmcnt(1)
    v_mov_b32 v63, 0
    v_dot2c_f32_bf16 v63, v112, v40
    v_dot2c_f32_bf16 v63, v113, v41
    v_dot2c_f32_bf16 v63, v114, v42
    v_dot2c_f32_bf16 v63, v115, v43
    v_dot2c_f32_bf16 v63, v116, v44
    v_dot2c_f32_bf16 v63, v117, v45
    v_dot2c_f32_bf16 v63, v118, v46
    v_dot2c_f32_bf16 v63, v119, v47
    v_dot2c_f32_bf16 v63, v120, v48
    v_dot2c_f32_bf16 v63, v121, v49
    v_dot2c_f32_bf16 v63, v122, v50
    v_dot2c_f32_bf16 v63, v123, v51
    buffer_load_dwordx4 v[136:139], v4, s[4:7], s48 offen offset:0 nt
    buffer_load_dwordx4 v[140:143], v4, s[4:7], s48 offen offset:128 nt
    buffer_load_dwordx4 v[144:147], v4, s[4:7], s48 offen offset:256 nt
    s_add_u32 s48, s48, 3072
    v_add_f32_dpp v63, v63, v63 quad_perm:[1,0,3,2] row_mask:0xf bank_mask:0xf
    s_nop 1
    v_add_f32_dpp v63, v63, v63 quad_perm:[2,3,0,1] row_mask:0xf bank_mask:0xf
    s_nop 1
    v_add_f32_dpp v63, v63, v63 row_half_mirror row_mask:0xf bank_mask:0xf
    v_cvt_pk_bf16_f32 v63, v63, v63
    v_and_b32 v63, 0xffff0000, v63
    v_mul_f32 v63, s54, v63
    v_cvt_pk_bf16_f32 v63, v63, v63
    v_and_b32 v63, 0xffff0000, v63
    s_waitcnt vmcnt(1)
    v_mov_b32 v64, 0
    v_dot2c_f32_bf16 v64, v124, v40
    v_dot2c_f32_bf16 v64, v125, v41
    v_dot2c_f32_bf16 v64, v126, v42
    v_dot2c_f32_bf16 v64, v127, v43
    v_dot2c_f32_bf16 v64, v128, v44
    v_dot2c_f32_bf16 v64, v129, v45
    v_dot2c_f32_bf16 v64, v130, v46
    v_dot2c_f32_bf16 v64, v131, v47
    v_dot2c_f32_bf16 v64, v132, v48
    v_dot2c_f32_bf16 v64, v133, v49
    v_dot2c_f32_bf16 v64, v134, v50
    v_dot2c_f32_bf16 v64, v135, v51
    buffer_load_dwordx4 v[148:151], v4, s[4:7], s48 offen offset:0 nt
    buffer_load_dwordx4 v[152:155], v4, s[4:7], s48 offen offset:128 nt
    buffer_load_dwordx4 v[156:159], v4, s[4:7], s48 offen offset:256 nt
    s_add_u32 s48, s48, 3072
    v_add_f32_dpp v64, v64, v64 quad_perm:[1,0,3,2] row_mask:0xf bank_mask:0xf
    s_nop 1
    v_add_f32_dpp v64, v64, v64 quad_perm:[2,3,0,1] row_mask:0xf bank_mask:0xf
    s_nop 1
    v_add_f32_dpp v64, v64, v64 row_half_mirror row_mask:0xf bank_mask:0xf
    v_cvt_pk_bf16_f32 v64, v64, v64
    v_and_b32 v64, 0xffff0000, v64
    v_mul_f32 v64, s54, v64
    v_cvt_pk_bf16_f32 v64, v64, v64
    v_and_b32 v64, 0xffff0000, v64
    s_waitcnt vmcnt(1)
    v_mov_b32 v65, 0
    v_dot2c_f32_bf16 v65, v136, v40
    v_dot2c_f32_bf16 v65, v137, v41
    v_dot2c_f32_bf16 v65, v138, v42
    v_dot2c_f32_bf16 v65, v139, v43
    v_dot2c_f32_bf16 v65, v140, v44
    v_dot2c_f32_bf16 v65, v141, v45
    v_dot2c_f32_bf16 v65, v142, v46
    v_dot2c_f32_bf16 v65, v143, v47
    v_dot2c_f32_bf16 v65, v144, v48
    v_dot2c_f32_bf16 v65, v145, v49
    v_dot2c_f32_bf16 v65, v146, v50
    v_dot2c_f32_bf16 v65, v147, v51
    buffer_load_dwordx4 v[160:163], v4, s[4:7], s48 offen offset:0 nt
    buffer_load_dwordx4 v[164:167], v4, s[4:7], s48 offen offset:128 nt
    buffer_load_dwordx4 v[168:171], v4, s[4:7], s48 offen offset:256 nt
    s_add_u32 s48, s48, 3072
    v_add_f32_dpp v65, v65, v65 quad_perm:[1,0,3,2] row_mask:0xf bank_mask:0xf
    s_nop 1
    v_add_f32_dpp v65, v65, v65 quad_perm:[2,3,0,1] row_mask:0xf bank_mask:0xf
    s_nop 1
    v_add_f32_dpp v65, v65, v65 row_half_mirror row_mask:0xf bank_mask:0xf
    v_cvt_pk_bf16_f32 v65, v65, v65
    v_and_b32 v65, 0xffff0000, v65
    v_mul_f32 v65, s54, v65
    v_cvt_pk_bf16_f32 v65, v65, v65
    v_and_b32 v65, 0xffff0000, v65
    s_waitcnt vmcnt(1)
    v_mov_b32 v66, 0
    v_dot2c_f32_bf16 v66, v148, v40
    v_dot2c_f32_bf16 v66, v149, v41
    v_dot2c_f32_bf16 v66, v150, v42
    v_dot2c_f32_bf16 v66, v151, v43
    v_dot2c_f32_bf16 v66, v152, v44
    v_dot2c_f32_bf16 v66, v153, v45
    v_dot2c_f32_bf16 v66, v154, v46
    v_dot2c_f32_bf16 v66, v155, v47
    v_dot2c_f32_bf16 v66, v156, v48
    v_dot2c_f32_bf16 v66, v157, v49
    v_dot2c_f32_bf16 v66, v158, v50
    v_dot2c_f32_bf16 v66, v159, v51
    s_add_u32 s48, s99, 2
    s_and_b32 s48, s48, 3
    s_mul_i32 s48, s48, 196608
    s_add_u32 s48, s48, s49
    buffer_load_dwordx4 v[172:175], v4, s[4:7], s48 offen offset:0 nt
    buffer_load_dwordx4 v[176:179], v4, s[4:7], s48 offen offset:128 nt
    buffer_load_dwordx4 v[180:183], v4, s[4:7], s48 offen offset:256 nt
    s_add_u32 s48, s48, 3072
    v_add_f32_dpp v66, v66, v66 quad_perm:[1,0,3,2] row_mask:0xf bank_mask:0xf
    s_nop 1
    v_add_f32_dpp v66, v66, v66 quad_perm:[2,3,0,1] row_mask:0xf bank_mask:0xf
    s_nop 1
    v_add_f32_dpp v66, v66, v66 row_half_mirror row_mask:0xf bank_mask:0xf
    v_cvt_pk_bf16_f32 v66, v66, v66
    v_and_b32 v66, 0xffff0000, v66
    v_mul_f32 v66, s54, v66
    v_cvt_pk_bf16_f32 v66, v66, v66
    v_and_b32 v66, 0xffff0000, v66
    s_cmp_ge_u32 s46, 3
    s_cbranch_scc1 L_nowd
    s_lshr_b32 s58, s44, 3
    s_mul_i32 s58, s58, 3
    s_add_u32 s58, s58, s46
    s_mul_i32 s59, s57, 12
    s_add_u32 s58, s58, s59
    s_mul_i32 s58, s58, 20480
    s_mul_i32 s59, s3, 3072
    v_lshlrev_b32 v7, 4, v1
    v_add_u32 v7, s59, v7
    s_add_u32 s59, s59, 36864
    v_min_u32 v8, 20464, v7
    s_mov_b32 m0, s59
    s_nop 0
    buffer_load_dwordx4 v8, s[36:39], s58 offen nt lds
    v_add_u32 v7, 1024, v7
    s_add_u32 s59, s59, 1024
    v_min_u32 v8, 20464, v7
    s_mov_b32 m0, s59
    s_nop 0
    buffer_load_dwordx4 v8, s[36:39], s58 offen nt lds
    v_add_u32 v7, 1024, v7
    s_add_u32 s59, s59, 1024
    v_min_u32 v8, 20464, v7
    s_mov_b32 m0, s59
    s_nop 0
    buffer_load_dwordx4 v8, s[36:39], s58 offen nt lds
L_nowd:
    s_nop 4
    s_waitcnt vmcnt(1)
    v_mov_b32 v67, 0
    v_dot2c_f32_bf16 v67, v160, v40
    v_dot2c_f32_bf16 v67, v161, v41
    v_dot2c_f32_bf16 v67, v162, v42
    v_dot2c_f32_bf16 v67, v163, v43
    v_dot2c_f32_bf16 v67, v164, v44
    v_dot2c_f32_bf16 v67, v165, v45
    v_dot2c_f32_bf16 v67, v166, v46
    v_dot2c_f32_bf16 v67, v167, v47
    v_dot2c_f32_bf16 v67, v168, v48
    v_dot2c_f32_bf16 v67, v169, v49
    v_dot2c_f32_bf16 v67, v170, v50
    v_dot2c_f32_bf16 v67, v171, v51
    buffer_load_dwordx4 v[184:187], v4, s[4:7], s48 offen offset:0 nt
    buffer_load_dwordx4 v[188:191], v4, s[4:7], s48 offen offset:128 nt
    buffer_load_dwordx4 v[192:195], v4, s[4:7], s48 offen offset:256 nt
    s_add_u32 s48, s48, 3072
    v_add_f32_dpp v67, v67, v67 quad_perm:[1,0,3,2] row_mask:0xf bank_mask:0xf
    s_nop 1
    v_add_f32_dpp v67, v67, v67 quad_perm:[2,3,0,1] row_mask:0xf bank_mask:0xf
    s_nop 1
    v_add_f32_dpp v67, v67, v67 row_half_mirror row_mask:0xf bank_mask:0xf
    v_cvt_pk_bf16_f32 v67, v67, v67
    v_and_b32 v67, 0xffff0000, v67
    v_mul_f32 v67, s54, v67
    v_cvt_pk_bf16_f32 v67, v67, v67
    v_and_b32 v67, 0xffff0000, v67
    s_waitcnt vmcnt(1)
    v_mov_b32 v68, 0
    v_dot2c_f32_bf16 v68, v172, v40
    v_dot2c_f32_bf16 v68, v173, v41
    v_dot2c_f32_bf16 v68, v174, v42
    v_dot2c_f32_bf16 v68, v175, v43
    v_dot2c_f32_bf16 v68, v176, v44
    v_dot2c_f32_bf16 v68, v177, v45
    v_dot2c_f32_bf16 v68, v178, v46
    v_dot2c_f32_bf16 v68, v179, v47
    v_dot2c_f32_bf16 v68, v180, v48
    v_dot2c_f32_bf16 v68, v181, v49
    v_dot2c_f32_bf16 v68, v182, v50
    v_dot2c_f32_bf16 v68, v183, v51
    buffer_load_dwordx4 v[196:199], v4, s[4:7], s48 offen offset:0 nt
    buffer_load_dwordx4 v[200:203], v4, s[4:7], s48 offen offset:128 nt
    buffer_load_dwordx4 v[204:207], v4, s[4:7], s48 offen offset:256 nt
    s_add_u32 s48, s48, 3072
    v_add_f32_dpp v68, v68, v68 quad_perm:[1,0,3,2] row_mask:0xf bank_mask:0xf
    s_nop 1
    v_add_f32_dpp v68, v68, v68 quad_perm:[2,3,0,1] row_mask:0xf bank_mask:0xf
    s_nop 1
    v_add_f32_dpp v68, v68, v68 row_half_mirror row_mask:0xf bank_mask:0xf
    v_cvt_pk_bf16_f32 v68, v68, v68
    v_and_b32 v68, 0xffff0000, v68
    v_mul_f32 v68, s54, v68
    v_cvt_pk_bf16_f32 v68, v68, v68
    v_and_b32 v68, 0xffff0000, v68
    s_waitcnt vmcnt(1)
    v_mov_b32 v69, 0
    v_dot2c_f32_bf16 v69, v184, v40
    v_dot2c_f32_bf16 v69, v185, v41
    v_dot2c_f32_bf16 v69, v186, v42
    v_dot2c_f32_bf16 v69, v187, v43
    v_dot2c_f32_bf16 v69, v188, v44
    v_dot2c_f32_bf16 v69, v189, v45
    v_dot2c_f32_bf16 v69, v190, v46
    v_dot2c_f32_bf16 v69, v191, v47
    v_dot2c_f32_bf16 v69, v192, v48
    v_dot2c_f32_bf16 v69, v193, v49
    v_dot2c_f32_bf16 v69, v194, v50
    v_dot2c_f32_bf16 v69, v195, v51
    buffer_load_dwordx4 v[208:211], v4, s[4:7], s48 offen offset:0 nt
    buffer_load_dwordx4 v[212:215], v4, s[4:7], s48 offen offset:128 nt
    buffer_load_dwordx4 v[216:219], v4, s[4:7], s48 offen offset:256 nt
    s_add_u32 s48, s48, 3072
    v_add_f32_dpp v69, v69, v69 quad_perm:[1,0,3,2] row_mask:0xf bank_mask:0xf
    s_nop 1
    v_add_f32_dpp v69, v69, v69 quad_perm:[2,3,0,1] row_mask:0xf bank_mask:0xf
    s_nop 1
    v_add_f32_dpp v69, v69, v69 row_half_mirror row_mask:0xf bank_mask:0xf
    v_cvt_pk_bf16_f32 v69, v69, v69
    v_and_b32 v69, 0xffff0000, v69
    v_mul_f32 v69, s54, v69
    v_cvt_pk_bf16_f32 v69, v69, v69
    v_and_b32 v69, 0xffff0000, v69
    s_waitcnt vmcnt(1)
    v_mov_b32 v70, 0
    v_dot2c_f32_bf16 v70, v196, v40
    v_dot2c_f32_bf16 v70, v197, v41
    v_dot2c_f32_bf16 v70, v198, v42
    v_dot2c_f32_bf16 v70, v199, v43
    v_dot2c_f32_bf16 v70, v200, v44
    v_dot2c_f32_bf16 v70, v201, v45
    v_dot2c_f32_bf16 v70, v202, v46
    v_dot2c_f32_bf16 v70, v203, v47
    v_dot2c_f32_bf16 v70, v204, v48
    v_dot2c_f32_bf16 v70, v205, v49
    v_dot2c_f32_bf16 v70, v206, v50
    v_dot2c_f32_bf16 v70, v207, v51
    buffer_load_dwordx4 v[224:227], v4, s[4:7], s48 offen offset:0 nt
    buffer_load_dwordx4 v[228:231], v4, s[4:7], s48 offen offset:128 nt
    buffer_load_dwordx4 v[232:235], v4, s[4:7], s48 offen offset:256 nt
    s_add_u32 s48, s48, 3072
    v_add_f32_dpp v70, v70, v70 quad_perm:[1,0,3,2] row_mask:0xf bank_mask:0xf
    s_nop 1
    v_add_f32_dpp v70, v70, v70 quad_perm:[2,3,0,1] row_mask:0xf bank_mask:0xf
    s_nop 1
    v_add_f32_dpp v70, v70, v70 row_half_mirror row_mask:0xf bank_mask:0xf
    v_cvt_pk_bf16_f32 v70, v70, v70
    v_and_b32 v70, 0xffff0000, v70
    v_mul_f32 v70, s54, v70
    v_cvt_pk_bf16_f32 v70, v70, v70
    v_and_b32 v70, 0xffff0000, v70
    s_waitcnt vmcnt(1)
    v_mov_b32 v71, 0
    v_dot2c_f32_bf16 v71, v208, v40
    v_dot2c_f32_bf16 v71, v209, v41
    v_dot2c_f32_bf16 v71, v210, v42
    v_dot2c_f32_bf16 v71, v211, v43
    v_dot2c_f32_bf16 v71, v212, v44
    v_dot2c_f32_bf16 v71, v213, v45
    v_dot2c_f32_bf16 v71, v214, v46
    v_dot2c_f32_bf16 v71, v215, v47
    v_dot2c_f32_bf16 v71, v216, v48
    v_dot2c_f32_bf16 v71, v217, v49
    v_dot2c_f32_bf16 v71, v218, v50
    v_dot2c_f32_bf16 v71, v219, v51
    buffer_load_dwordx4 v[236:239], v4, s[4:7], s48 offen offset:0 nt
    buffer_load_dwordx4 v[240:243], v4, s[4:7], s48 offen offset:128 nt
    buffer_load_dwordx4 v[244:247], v4, s[4:7], s48 offen offset:256 nt
    s_add_u32 s48, s48, 3072
    v_add_f32_dpp v71, v71, v71 quad_perm:[1,0,3,2] row_mask:0xf bank_mask:0xf
    s_nop 1
    v_add_f32_dpp v71, v71, v71 quad_perm:[2,3,0,1] row_mask:0xf bank_mask:0xf
    s_nop 1
    v_add_f32_dpp v71, v71, v71 row_half_mirror row_mask:0xf bank_mask:0xf
    v_cvt_pk_bf16_f32 v71, v71, v71
    v_and_b32 v71, 0xffff0000, v71
    v_mul_f32 v71, s54, v71
    v_cvt_pk_bf16_f32 v71, v71, v71
    v_and_b32 v71, 0xffff0000, v71
    s_waitcnt vmcnt(1)
    v_mov_b32 v72, 0
    v_dot2c_f32_bf16 v72, v224, v40
    v_dot2c_f32_bf16 v72, v225, v41
    v_dot2c_f32_bf16 v72, v226, v42
    v_dot2c_f32_bf16 v72, v227, v43
    v_dot2c_f32_bf16 v72, v228, v44
    v_dot2c_f32_bf16 v72, v229, v45
    v_dot2c_f32_bf16 v72, v230, v46
    v_dot2c_f32_bf16 v72, v231, v47
    v_dot2c_f32_bf16 v72, v232, v48
    v_dot2c_f32_bf16 v72, v233, v49
    v_dot2c_f32_bf16 v72, v234, v50
    v_dot2c_f32_bf16 v72, v235, v51
    buffer_load_dwordx4 v[112:115], v4, s[4:7], s48 offen offset:0 nt
    buffer_load_dwordx4 v[116:119], v4, s[4:7], s48 offen offset:128 nt
    buffer_load_dwordx4 v[120:123], v4, s[4:7], s48 offen offset:256 nt
    s_add_u32 s48, s48, 3072
    v_add_f32_dpp v72, v72, v72 quad_perm:[1,0,3,2] row_mask:0xf bank_mask:0xf
    s_nop 1
    v_add_f32_dpp v72, v72, v72 quad_perm:[2,3,0,1] row_mask:0xf bank_mask:0xf
    s_nop 1
    v_add_f32_dpp v72, v72, v72 row_half_mirror row_mask:0xf bank_mask:0xf
    v_cvt_pk_bf16_f32 v72, v72, v72
    v_and_b32 v72, 0xffff0000, v72
    v_mul_f32 v72, s54, v72
    v_cvt_pk_bf16_f32 v72, v72, v72
    v_and_b32 v72, 0xffff0000, v72
    v_mov_b32 v7, 9728
    v_mov_b32 v8, 1
    s_mov_b64 exec, 1
    ds_add_u32 v7, v8
    s_mov_b64 exec, -1
    s_waitcnt vmcnt(1)
    v_mov_b32 v73, 0
    v_dot2c_f32_bf16 v73, v236, v40
    v_dot2c_f32_bf16 v73, v237, v41
    v_dot2c_f32_bf16 v73, v238, v42
    v_dot2c_f32_bf16 v73, v239, v43
    v_dot2c_f32_bf16 v73, v240, v44
    v_dot2c_f32_bf16 v73, v241, v45
    v_dot2c_f32_bf16 v73, v242, v46
    v_dot2c_f32_bf16 v73, v243, v47
    v_dot2c_f32_bf16 v73, v244, v48
    v_dot2c_f32_bf16 v73, v245, v49
    v_dot2c_f32_bf16 v73, v246, v50
    v_dot2c_f32_bf16 v73, v247, v51
    buffer_load_dwordx4 v[124:127], v4, s[4:7], s48 offen offset:0 nt
    buffer_load_dwordx4 v[128:131], v4, s[4:7], s48 offen offset:128 nt
    buffer_load_dwordx4 v[132:135], v4, s[4:7], s48 offen offset:256 nt
    s_add_u32 s48, s48, 3072
    v_add_f32_dpp v73, v73, v73 quad_perm:[1,0,3,2] row_mask:0xf bank_mask:0xf
    s_nop 1
    v_add_f32_dpp v73, v73, v73 quad_perm:[2,3,0,1] row_mask:0xf bank_mask:0xf
    s_nop 1
    v_add_f32_dpp v73, v73, v73 row_half_mirror row_mask:0xf bank_mask:0xf
    v_cvt_pk_bf16_f32 v73, v73, v73
    v_and_b32 v73, 0xffff0000, v73
    v_mul_f32 v73, s54, v73
    v_cvt_pk_bf16_f32 v73, v73, v73
    v_and_b32 v73, 0xffff0000, v73
    s_waitcnt vmcnt(1)
    v_mov_b32 v74, 0
    v_dot2c_f32_bf16 v74, v112, v40
    v_dot2c_f32_bf16 v74, v113, v41
    v_dot2c_f32_bf16 v74, v114, v42
    v_dot2c_f32_bf16 v74, v115, v43
    v_dot2c_f32_bf16 v74, v116, v44
    v_dot2c_f32_bf16 v74, v117, v45
    v_dot2c_f32_bf16 v74, v118, v46
    v_dot2c_f32_bf16 v74, v119, v47
    v_dot2c_f32_bf16 v74, v120, v48
    v_dot2c_f32_bf16 v74, v121, v49
    v_dot2c_f32_bf16 v74, v122, v50
    v_dot2c_f32_bf16 v74, v123, v51
    s_add_u32 s48, s99, 3
    s_and_b32 s48, s48, 3
    s_mul_i32 s48, s48, 196608
    s_add_u32 s48, s48, s49
    buffer_load_dwordx4 v[136:139], v4, s[4:7], s48 offen offset:0 nt
    buffer_load_dwordx4 v[140:143], v4, s[4:7], s48 offen offset:128 nt
    buffer_load_dwordx4 v[144:147], v4, s[4:7], s48 offen offset:256 nt
    s_add_u32 s48, s48, 3072
    v_add_f32_dpp v74, v74, v74 quad_perm:[1,0,3,2] row_mask:0xf bank_mask:0xf
    s_nop 1
    v_add_f32_dpp v74, v74, v74 quad_perm:[2,3,0,1] row_mask:0xf bank_mask:0xf
    s_nop 1
    v_add_f32_dpp v74, v74, v74 row_half_mirror row_mask:0xf bank_mask:0xf
    v_cvt_pk_bf16_f32 v74, v74, v74
    v_and_b32 v74, 0xffff0000, v74
    v_mul_f32 v74, s54, v74
    v_cvt_pk_bf16_f32 v74, v74, v74
    v_and_b32 v74, 0xffff0000, v74
    s_waitcnt vmcnt(1)
    v_mov_b32 v75, 0
    v_dot2c_f32_bf16 v75, v124, v40
    v_dot2c_f32_bf16 v75, v125, v41
    v_dot2c_f32_bf16 v75, v126, v42
    v_dot2c_f32_bf16 v75, v127, v43
    v_dot2c_f32_bf16 v75, v128, v44
    v_dot2c_f32_bf16 v75, v129, v45
    v_dot2c_f32_bf16 v75, v130, v46
    v_dot2c_f32_bf16 v75, v131, v47
    v_dot2c_f32_bf16 v75, v132, v48
    v_dot2c_f32_bf16 v75, v133, v49
    v_dot2c_f32_bf16 v75, v134, v50
    v_dot2c_f32_bf16 v75, v135, v51
    buffer_load_dwordx4 v[148:151], v4, s[4:7], s48 offen offset:0 nt
    buffer_load_dwordx4 v[152:155], v4, s[4:7], s48 offen offset:128 nt
    buffer_load_dwordx4 v[156:159], v4, s[4:7], s48 offen offset:256 nt
    s_add_u32 s48, s48, 3072
    v_add_f32_dpp v75, v75, v75 quad_perm:[1,0,3,2] row_mask:0xf bank_mask:0xf
    s_nop 1
    v_add_f32_dpp v75, v75, v75 quad_perm:[2,3,0,1] row_mask:0xf bank_mask:0xf
    s_nop 1
    v_add_f32_dpp v75, v75, v75 row_half_mirror row_mask:0xf bank_mask:0xf
    v_cvt_pk_bf16_f32 v75, v75, v75
    v_and_b32 v75, 0xffff0000, v75
    v_mul_f32 v75, s54, v75
    v_cvt_pk_bf16_f32 v75, v75, v75
    v_and_b32 v75, 0xffff0000, v75
    s_waitcnt vmcnt(1)
    v_mov_b32 v76, 0
    v_dot2c_f32_bf16 v76, v136, v40
    v_dot2c_f32_bf16 v76, v137, v41
    v_dot2c_f32_bf16 v76, v138, v42
    v_dot2c_f32_bf16 v76, v139, v43
    v_dot2c_f32_bf16 v76, v140, v44
    v_dot2c_f32_bf16 v76, v141, v45
    v_dot2c_f32_bf16 v76, v142, v46
    v_dot2c_f32_bf16 v76, v143, v47
    v_dot2c_f32_bf16 v76, v144, v48
    v_dot2c_f32_bf16 v76, v145, v49
    v_dot2c_f32_bf16 v76, v146, v50
    v_dot2c_f32_bf16 v76, v147, v51
    buffer_load_dwordx4 v[160:163], v4, s[4:7], s48 offen offset:0 nt
    buffer_load_dwordx4 v[164:167], v4, s[4:7], s48 offen offset:128 nt
    buffer_load_dwordx4 v[168:171], v4, s[4:7], s48 offen offset:256 nt
    s_add_u32 s48, s48, 3072
    v_add_f32_dpp v76, v76, v76 quad_perm:[1,0,3,2] row_mask:0xf bank_mask:0xf
    s_nop 1
    v_add_f32_dpp v76, v76, v76 quad_perm:[2,3,0,1] row_mask:0xf bank_mask:0xf
    s_nop 1
    v_add_f32_dpp v76, v76, v76 row_half_mirror row_mask:0xf bank_mask:0xf
    v_cvt_pk_bf16_f32 v76, v76, v76
    v_and_b32 v76, 0xffff0000, v76
    v_mul_f32 v76, s54, v76
    v_cvt_pk_bf16_f32 v76, v76, v76
    v_and_b32 v76, 0xffff0000, v76
    s_waitcnt vmcnt(1)
    v_mov_b32 v77, 0
    v_dot2c_f32_bf16 v77, v148, v40
    v_dot2c_f32_bf16 v77, v149, v41
    v_dot2c_f32_bf16 v77, v150, v42
    v_dot2c_f32_bf16 v77, v151, v43
    v_dot2c_f32_bf16 v77, v152, v44
    v_dot2c_f32_bf16 v77, v153, v45
    v_dot2c_f32_bf16 v77, v154, v46
    v_dot2c_f32_bf16 v77, v155, v47
    v_dot2c_f32_bf16 v77, v156, v48
    v_dot2c_f32_bf16 v77, v157, v49
    v_dot2c_f32_bf16 v77, v158, v50
    v_dot2c_f32_bf16 v77, v159, v51
    buffer_load_dwordx4 v[172:175], v4, s[4:7], s48 offen offset:0 nt
    buffer_load_dwordx4 v[176:179], v4, s[4:7], s48 offen offset:128 nt
    buffer_load_dwordx4 v[180:183], v4, s[4:7], s48 offen offset:256 nt
    s_add_u32 s48, s48, 3072
    v_add_f32_dpp v77, v77, v77 quad_perm:[1,0,3,2] row_mask:0xf bank_mask:0xf
    s_nop 1
    v_add_f32_dpp v77, v77, v77 quad_perm:[2,3,0,1] row_mask:0xf bank_mask:0xf
    s_nop 1
    v_add_f32_dpp v77, v77, v77 row_half_mirror row_mask:0xf bank_mask:0xf
    v_cvt_pk_bf16_f32 v77, v77, v77
    v_and_b32 v77, 0xffff0000, v77
    v_mul_f32 v77, s54, v77
    v_cvt_pk_bf16_f32 v77, v77, v77
    v_and_b32 v77, 0xffff0000, v77
    s_waitcnt vmcnt(1)
    v_mov_b32 v78, 0
    v_dot2c_f32_bf16 v78, v160, v40
    v_dot2c_f32_bf16 v78, v161, v41
    v_dot2c_f32_bf16 v78, v162, v42
    v_dot2c_f32_bf16 v78, v163, v43
    v_dot2c_f32_bf16 v78, v164, v44
    v_dot2c_f32_bf16 v78, v165, v45
    v_dot2c_f32_bf16 v78, v166, v46
    v_dot2c_f32_bf16 v78, v167, v47
    v_dot2c_f32_bf16 v78, v168, v48
    v_dot2c_f32_bf16 v78, v169, v49
    v_dot2c_f32_bf16 v78, v170, v50
    v_dot2c_f32_bf16 v78, v171, v51
    buffer_load_dwordx4 v[184:187], v4, s[4:7], s48 offen offset:0 nt
    buffer_load_dwordx4 v[188:191], v4, s[4:7], s48 offen offset:128 nt
    buffer_load_dwordx4 v[192:195], v4, s[4:7], s48 offen offset:256 nt
    s_add_u32 s48, s48, 3072
    v_add_f32_dpp v78, v78, v78 quad_perm:[1,0,3,2] row_mask:0xf bank_mask:0xf
    s_nop 1
    v_add_f32_dpp v78, v78, v78 quad_perm:[2,3,0,1] row_mask:0xf bank_mask:0xf
    s_nop 1
    v_add_f32_dpp v78, v78, v78 row_half_mirror row_mask:0xf bank_mask:0xf
    v_cvt_pk_bf16_f32 v78, v78, v78
    v_and_b32 v78, 0xffff0000, v78
    v_mul_f32 v78, s54, v78
    v_cvt_pk_bf16_f32 v78, v78, v78
    v_and_b32 v78, 0xffff0000, v78
    v_cmp_eq_u32 vcc, 0, v3
    s_nop 1
    v_cndmask_b32 v94, v94, v78, vcc
    s_waitcnt vmcnt(1)
    v_mov_b32 v79, 0
    v_dot2c_f32_bf16 v79, v172, v40
    v_dot2c_f32_bf16 v79, v173, v41
    v_dot2c_f32_bf16 v79, v174, v42
    v_dot2c_f32_bf16 v79, v175, v43
    v_dot2c_f32_bf16 v79, v176, v44
    v_dot2c_f32_bf16 v79, v177, v45
    v_dot2c_f32_bf16 v79, v178, v46
    v_dot2c_f32_bf16 v79, v179, v47
    v_dot2c_f32_bf16 v79, v180, v48
    v_dot2c_f32_bf16 v79, v181, v49
    v_dot2c_f32_bf16 v79, v182, v50
    v_dot2c_f32_bf16 v79, v183, v51
    buffer_load_dwordx4 v[196:199], v4, s[4:7], s48 offen offset:0 nt
    buffer_load_dwordx4 v[200:203], v4, s[4:7], s48 offen offset:128 nt
    buffer_load_dwordx4 v[204:207], v4, s[4:7], s48 offen offset:256 nt
    s_add_u32 s48, s48, 3072
    v_add_f32_dpp v79, v79, v79 quad_perm:[1,0,3,2] row_mask:0xf bank_mask:0xf
    s_nop 1
    v_add_f32_dpp v79, v79, v79 quad_perm:[2,3,0,1] row_mask:0xf bank_mask:0xf
    s_nop 1
    v_add_f32_dpp v79, v79, v79 row_half_mirror row_mask:0xf bank_mask:0xf
    v_cvt_pk_bf16_f32 v79, v79, v79
    v_and_b32 v79, 0xffff0000, v79
    v_mul_f32 v79, s54, v79
    v_cvt_pk_bf16_f32 v79, v79, v79
    v_and_b32 v79, 0xffff0000, v79
    v_cmp_eq_u32 vcc, 1, v3
    s_nop 1
    v_cndmask_b32 v94, v94, v79, vcc
    s_waitcnt vmcnt(1)
    v_mov_b32 v80, 0
    v_dot2c_f32_bf16 v80, v184, v40
    v_dot2c_f32_bf16 v80, v185, v41
    v_dot2c_f32_bf16 v80, v186, v42
    v_dot2c_f32_bf16 v80, v187, v43
    v_dot2c_f32_bf16 v80, v188, v44
    v_dot2c_f32_bf16 v80, v189, v45
    v_dot2c_f32_bf16 v80, v190, v46
    v_dot2c_f32_bf16 v80, v191, v47
    v_dot2c_f32_bf16 v80, v192, v48
    v_dot2c_f32_bf16 v80, v193, v49
    v_dot2c_f32_bf16 v80, v194, v50
    v_dot2c_f32_bf16 v80, v195, v51
    buffer_load_dwordx4 v[208:211], v4, s[4:7], s48 offen offset:0 nt
    buffer_load_dwordx4 v[212:215], v4, s[4:7], s48 offen offset:128 nt
    buffer_load_dwordx4 v[216:219], v4, s[4:7], s48 offen offset:256 nt
    s_add_u32 s48, s48, 3072
    v_add_f32_dpp v80, v80, v80 quad_perm:[1,0,3,2] row_mask:0xf bank_mask:0xf
    s_nop 1
    v_add_f32_dpp v80, v80, v80 quad_perm:[2,3,0,1] row_mask:0xf bank_mask:0xf
    s_nop 1
    v_add_f32_dpp v80, v80, v80 row_half_mirror row_mask:0xf bank_mask:0xf
    v_cvt_pk_bf16_f32 v80, v80, v80
    v_and_b32 v80, 0xffff0000, v80
    v_mul_f32 v80, s54, v80
    v_cvt_pk_bf16_f32 v80, v80, v80
    v_and_b32 v80, 0xffff0000, v80
    v_cmp_eq_u32 vcc, 2, v3
    s_nop 1
    v_cndmask_b32 v94, v94, v80, vcc
    s_waitcnt vmcnt(1)
    v_mov_b32 v81, 0
    v_dot2c_f32_bf16 v81, v196, v40
    v_dot2c_f32_bf16 v81, v197, v41
    v_dot2c_f32_bf16 v81, v198, v42
    v_dot2c_f32_bf16 v81, v199, v43
    v_dot2c_f32_bf16 v81, v200, v44
    v_dot2c_f32_bf16 v81, v201, v45
    v_dot2c_f32_bf16 v81, v202, v46
    v_dot2c_f32_bf16 v81, v203, v47
    v_dot2c_f32_bf16 v81, v204, v48
    v_dot2c_f32_bf16 v81, v205, v49
    v_dot2c_f32_bf16 v81, v206, v50
    v_dot2c_f32_bf16 v81, v207, v51
    buffer_load_dwordx4 v[224:227], v4, s[4:7], s48 offen offset:0 nt
    buffer_load_dwordx4 v[228:231], v4, s[4:7], s48 offen offset:128 nt
    buffer_load_dwordx4 v[232:235], v4, s[4:7], s48 offen offset:256 nt
    s_add_u32 s48, s48, 3072
    v_add_f32_dpp v81, v81, v81 quad_perm:[1,0,3,2] row_mask:0xf bank_mask:0xf
    s_nop 1
    v_add_f32_dpp v81, v81, v81 quad_perm:[2,3,0,1] row_mask:0xf bank_mask:0xf
    s_nop 1
    v_add_f32_dpp v81, v81, v81 row_half_mirror row_mask:0xf bank_mask:0xf
    v_cvt_pk_bf16_f32 v81, v81, v81
    v_and_b32 v81, 0xffff0000, v81
    v_mul_f32 v81, s54, v81
    v_cvt_pk_bf16_f32 v81, v81, v81
    v_and_b32 v81, 0xffff0000, v81
    v_cmp_eq_u32 vcc, 3, v3
    s_nop 1
    v_cndmask_b32 v94, v94, v81, vcc
    s_waitcnt vmcnt(1)
    v_mov_b32 v82, 0
    v_dot2c_f32_bf16 v82, v208, v40
    v_dot2c_f32_bf16 v82, v209, v41
    v_dot2c_f32_bf16 v82, v210, v42
    v_dot2c_f32_bf16 v82, v211, v43
    v_dot2c_f32_bf16 v82, v212, v44
    v_dot2c_f32_bf16 v82, v213, v45
    v_dot2c_f32_bf16 v82, v214, v46
    v_dot2c_f32_bf16 v82, v215, v47
    v_dot2c_f32_bf16 v82, v216, v48
    v_dot2c_f32_bf16 v82, v217, v49
    v_dot2c_f32_bf16 v82, v218, v50
    v_dot2c_f32_bf16 v82, v219, v51
    s_add_u32 s48, s99, 0
    s_and_b32 s48, s48, 3
    s_mul_i32 s48, s48, 196608
    s_add_u32 s48, s48, s49
    buffer_load_dwordx4 v[236:239], v4, s[8:11], s48 offen offset:0 nt
    buffer_load_dwordx4 v[240:243], v4, s[8:11], s48 offen offset:128 nt
    buffer_load_dwordx4 v[244:247], v4, s[8:11], s48 offen offset:256 nt
    s_add_u32 s48, s48, 3072
    v_add_f32_dpp v82, v82, v82 quad_perm:[1,0,3,2] row_mask:0xf bank_mask:0xf
    s_nop 1
    v_add_f32_dpp v82, v82, v82 quad_perm:[2,3,0,1] row_mask:0xf bank_mask:0xf
    s_nop 1
    v_add_f32_dpp v82, v82, v82 row_half_mirror row_mask:0xf bank_mask:0xf
    v_cvt_pk_bf16_f32 v82, v82, v82
    v_and_b32 v82, 0xffff0000, v82
    v_mul_f32 v82, s54, v82
    v_cvt_pk_bf16_f32 v82, v82, v82
    v_and_b32 v82, 0xffff0000, v82
    v_cmp_eq_u32 vcc, 4, v3
    s_nop 1
    v_cndmask_b32 v94, v94, v82, vcc
    s_waitcnt vmcnt(1)
    v_mov_b32 v83, 0
    v_dot2c_f32_bf16 v83, v224, v40
    v_dot2c_f32_bf16 v83, v225, v41
    v_dot2c_f32_bf16 v83, v226, v42
    v_dot2c_f32_bf16 v83, v227, v43
    v_dot2c_f32_bf16 v83, v228, v44
    v_dot2c_f32_bf16 v83, v229, v45
    v_dot2c_f32_bf16 v83, v230, v46
    v_dot2c_f32_bf16 v83, v231, v47
    v_dot2c_f32_bf16 v83, v232, v48
    v_dot2c_f32_bf16 v83, v233, v49
    v_dot2c_f32_bf16 v83, v234, v50
    v_dot2c_f32_bf16 v83, v235, v51
    buffer_load_dwordx4 v[112:115], v4, s[8:11], s48 offen offset:0 nt
    buffer_load_dwordx4 v[116:119], v4, s[8:11], s48 offen offset:128 nt
    buffer_load_dwordx4 v[120:123], v4, s[8:11], s48 offen offset:256 nt
    s_add_u32 s48, s48, 3072
    v_add_f32_dpp v83, v83, v83 quad_perm:[1,0,3,2] row_mask:0xf bank_mask:0xf
    s_nop 1
    v_add_f32_dpp v83, v83, v83 quad_perm:[2,3,0,1] row_mask:0xf bank_mask:0xf
    s_nop 1
    v_add_f32_dpp v83, v83, v83 row_half_mirror row_mask:0xf bank_mask:0xf
    v_cvt_pk_bf16_f32 v83, v83, v83
    v_and_b32 v83, 0xffff0000, v83
    v_mul_f32 v83, s54, v83
    v_cvt_pk_bf16_f32 v83, v83, v83
    v_and_b32 v83, 0xffff0000, v83
    v_cmp_eq_u32 vcc, 5, v3
    s_nop 1
    v_cndmask_b32 v94, v94, v83, vcc
    s_lshl_b32 s58, s40, 6
    s_add_u32 s58, s58, s41
    s_add_u32 s58, s58, 0
    buffer_store_dwordx2 v[94:95], v90, s[24:27], s58 offen sc1
    v_max3_f32 v84, v52, v53, v54
    v_max3_f32 v84, v84, v55, v56
    v_max3_f32 v84, v84, v57, v58
    v_max3_f32 v84, v84, v59, v60
    v_max3_f32 v84, v84, v61, v62
    v_max3_f32 v84, v84, v63, v64
    v_max3_f32 v84, v84, v65, v66
    v_max3_f32 v84, v84, v67, v68
    v_max3_f32 v84, v84, v69, v70
    v_max3_f32 v84, v84, v71, v72
    v_max3_f32 v84, v84, v73, v74
    v_max3_f32 v84, v84, v75, v76
    v_max3_f32 v84, v84, v77, v78
    v_max3_f32 v84, v84, v79, v80
    v_max3_f32 v84, v84, v81, v82
    v_max_f32 v84, v84, v83
    s_nop 1
    v_max_f32_dpp v84, v84, v84 row_ror:8 row_mask:0xf bank_mask:0xf
    v_mov_b32 v86, v84
    v_mov_b32 v87, v84
    s_nop 1
    v_permlane16_swap_b32 v86, v87
    v_max_f32 v84, v86, v87
    v_mov_b32 v86, v84
    v_mov_b32 v87, v84
    s_nop 1
    v_permlane32_swap_b32 v86, v87
    v_max_f32 v84, v86, v87
    v_sub_f32 v52, v52, v84
    v_sub_f32 v53, v53, v84
    v_sub_f32 v54, v54, v84
    v_sub_f32 v55, v55, v84
    v_sub_f32 v56, v56, v84
    v_sub_f32 v57, v57, v84
    v_sub_f32 v58, v58, v84
    v_sub_f32 v59, v59, v84
    v_sub_f32 v60, v60, v84
    v_sub_f32 v61, v61, v84
    v_sub_f32 v62, v62, v84
    v_sub_f32 v63, v63, v84
    v_sub_f32 v64, v64, v84
    v_sub_f32 v65, v65, v84
    v_sub_f32 v66, v66, v84
    v_sub_f32 v67, v67, v84
    v_sub_f32 v68, v68, v84
    v_sub_f32 v69, v69, v84
    v_sub_f32 v70, v70, v84
    v_sub_f32 v71, v71, v84
    v_sub_f32 v72, v72, v84
    v_sub_f32 v73, v73, v84
    v_sub_f32 v74, v74, v84
    v_sub_f32 v75, v75, v84
    v_sub_f32 v76, v76, v84
    v_sub_f32 v77, v77, v84
    v_sub_f32 v78, v78, v84
    v_sub_f32 v79, v79, v84
    v_sub_f32 v80, v80, v84
    v_sub_f32 v81, v81, v84
    v_sub_f32 v82, v82, v84
    v_sub_f32 v83, v83, v84
    v_mul_f32 v52, s53, v52
    v_mul_f32 v53, s53, v53
    v_mul_f32 v54, s53, v54
    v_mul_f32 v55, s53, v55
    v_mul_f32 v56, s53, v56
    v_mul_f32 v57, s53, v57
    v_mul_f32 v58, s53, v58
    v_mul_f32 v59, s53, v59
    v_mul_f32 v60, s53, v60
    v_mul_f32 v61, s53, v61
    v_mul_f32 v62, s53, v62
    v_mul_f32 v63, s53, v63
    v_mul_f32 v64, s53, v64
    v_mul_f32 v65, s53, v65
    v_mul_f32 v66, s53, v66
    v_mul_f32 v67, s53, v67
    v_mul_f32 v68, s53, v68
    v_mul_f32 v69, s53, v69
    v_mul_f32 v70, s53, v70
    v_mul_f32 v71, s53, v71
    v_mul_f32 v72, s53, v72
    v_mul_f32 v73, s53, v73
    v_mul_f32 v74, s53, v74
    v_mul_f32 v75, s53, v75
    v_mul_f32 v76, s53, v76
    v_mul_f32 v77, s53, v77
    v_mul_f32 v78, s53, v78
    v_mul_f32 v79, s53, v79
    v_mul_f32 v80, s53, v80
    v_mul_f32 v81, s53, v81
    v_mul_f32 v82, s53, v82
    v_mul_f32 v83, s53, v83
    v_exp_f32 v52, v52
    v_exp_f32 v53, v53
    v_exp_f32 v54, v54
    v_exp_f32 v55, v55
    v_exp_f32 v56, v56
    v_exp_f32 v57, v57
    v_exp_f32 v58, v58
    v_exp_f32 v59, v59
    v_exp_f32 v60, v60
    v_exp_f32 v61, v61
    v_exp_f32 v62, v62
    v_exp_f32 v63, v63
    v_exp_f32 v64, v64
    v_exp_f32 v65, v65
    v_exp_f32 v66, v66
    v_exp_f32 v67, v67
    v_exp_f32 v68, v68
    v_exp_f32 v69, v69
    v_exp_f32 v70, v70
    v_exp_f32 v71, v71
    v_exp_f32 v72, v72
    v_exp_f32 v73, v73
    v_exp_f32 v74, v74
    v_exp_f32 v75, v75
    v_exp_f32 v76, v76
    v_exp_f32 v77, v77
    v_exp_f32 v78, v78
    v_exp_f32 v79, v79
    v_exp_f32 v80, v80
    v_exp_f32 v81, v81
    v_exp_f32 v82, v82
    v_exp_f32 v83, v83
    v_mov_b32 v16, 0
    v_mov_b32 v17, 0
    v_mov_b32 v18, 0
    v_mov_b32 v19, 0
    v_mov_b32 v20, 0
    v_mov_b32 v21, 0
    v_mov_b32 v22, 0
    v_mov_b32 v23, 0
    v_mov_b32 v24, 0
    v_mov_b32 v25, 0
    v_mov_b32 v26, 0
    v_mov_b32 v27, 0
    v_mov_b32 v28, 0
    v_mov_b32 v29, 0
    v_mov_b32 v30, 0
    v_mov_b32 v31, 0
    v_mov_b32 v32, 0
    v_mov_b32 v33, 0
    v_mov_b32 v34, 0
    v_mov_b32 v35, 0
    v_mov_b32 v36, 0
    v_mov_b32 v37, 0
    v_mov_b32 v38, 0
    v_mov_b32 v39, 0
    v_add_f32 v42, v52, v53
    v_add_f32 v42, v42, v54
    v_add_f32 v42, v42, v55
    v_add_f32 v42, v42, v56
    v_add_f32 v42, v42, v57
    v_add_f32 v42, v42, v58
    v_add_f32 v42, v42, v59
    v_add_f32 v42, v42, v60
    v_add_f32 v42, v42, v61
    v_add_f32 v42, v42, v62
    v_add_f32 v42, v42, v63
    v_add_f32 v42, v42, v64
    v_add_f32 v42, v42, v65
    v_add_f32 v42, v42, v66
    v_add_f32 v42, v42, v67
    v_add_f32 v42, v42, v68
    v_add_f32 v42, v42, v69
    v_add_f32 v42, v42, v70
    v_add_f32 v42, v42, v71
    v_add_f32 v42, v42, v72
    v_add_f32 v42, v42, v73
    v_add_f32 v42, v42, v74
    v_add_f32 v42, v42, v75
    v_add_f32 v42, v42, v76
    v_add_f32 v42, v42, v77
    v_add_f32 v42, v42, v78
    v_add_f32 v42, v42, v79
    v_add_f32 v42, v42, v80
    v_add_f32 v42, v42, v81
    v_add_f32 v42, v42, v82
    v_add_f32 v42, v42, v83
    s_nop 1
    v_add_f32_dpp v42, v42, v42 row_ror:8 row_mask:0xf bank_mask:0xf
    v_mov_b32 v86, v42
    v_mov_b32 v87, v42
    s_nop 1
    v_permlane16_swap_b32 v86, v87
    v_add_f32 v42, v86, v87
    v_mov_b32 v86, v42
    v_mov_b32 v87, v42
    s_nop 1
    v_permlane32_swap_b32 v86, v87
    v_add_f32 v42, v86, v87
    v_mov_b32 v40, v84
    v_mov_b32 v41, s52
    v_mov_b32 v43, s52
    s_lshl_b32 s58, s40, 4
    s_add_u32 s58, s58, s65
    s_mov_b64 exec, 1
    buffer_store_dwordx4 v[40:43], v88, s[24:27], s58 offen sc1
    s_mov_b64 exec, -1
    s_waitcnt vmcnt(3)
    v_cvt_pk_bf16_f32 v7, v52, 0
    v_cvt_pk_bf16_f32 v8, 0, v52
    v_dot2c_f32_bf16 v16, v236, v7
    v_dot2c_f32_bf16 v17, v236, v8
    v_dot2c_f32_bf16 v18, v237, v7
    v_dot2c_f32_bf16 v19, v237, v8
    v_dot2c_f32_bf16 v20, v238, v7
    v_dot2c_f32_bf16 v21, v238, v8
    v_dot2c_f32_bf16 v22, v239, v7
    v_dot2c_f32_bf16 v23, v239, v8
    v_dot2c_f32_bf16 v24, v240, v7
    v_dot2c_f32_bf16 v25, v240, v8
    v_dot2c_f32_bf16 v26, v241, v7
    v_dot2c_f32_bf16 v27, v241, v8
    v_dot2c_f32_bf16 v28, v242, v7
    v_dot2c_f32_bf16 v29, v242, v8
    v_dot2c_f32_bf16 v30, v243, v7
    v_dot2c_f32_bf16 v31, v243, v8
    v_dot2c_f32_bf16 v32, v244, v7
    v_dot2c_f32_bf16 v33, v244, v8
    v_dot2c_f32_bf16 v34, v245, v7
    v_dot2c_f32_bf16 v35, v245, v8
    v_dot2c_f32_bf16 v36, v246, v7
    v_dot2c_f32_bf16 v37, v246, v8
    v_dot2c_f32_bf16 v38, v247, v7
    v_dot2c_f32_bf16 v39, v247, v8
    buffer_load_dwordx4 v[124:127], v4, s[8:11], s48 offen offset:0 nt
    buffer_load_dwordx4 v[128:131], v4, s[8:11], s48 offen offset:128 nt
    buffer_load_dwordx4 v[132:135], v4, s[8:11], s48 offen offset:256 nt
    s_add_u32 s48, s48, 3072
    s_waitcnt vmcnt(3)
    v_cvt_pk_bf16_f32 v7, v53, 0
    v_cvt_pk_bf16_f32 v8, 0, v53
    v_dot2c_f32_bf16 v16, v112, v7
    v_dot2c_f32_bf16 v17, v112, v8
    v_dot2c_f32_bf16 v18, v113, v7
    v_dot2c_f32_bf16 v19, v113, v8
    v_dot2c_f32_bf16 v20, v114, v7
    v_dot2c_f32_bf16 v21, v114, v8
    v_dot2c_f32_bf16 v22, v115, v7
    v_dot2c_f32_bf16 v23, v115, v8
    v_dot2c_f32_bf16 v24, v116, v7
    v_dot2c_f32_bf16 v25, v116, v8
    v_dot2c_f32_bf16 v26, v117, v7
    v_dot2c_f32_bf16 v27, v117, v8
    v_dot2c_f32_bf16 v28, v118, v7
    v_dot2c_f32_bf16 v29, v118, v8
    v_dot2c_f32_bf16 v30, v119, v7
    v_dot2c_f32_bf16 v31, v119, v8
    v_dot2c_f32_bf16 v32, v120, v7
    v_dot2c_f32_bf16 v33, v120, v8
    v_dot2c_f32_bf16 v34, v121, v7
    v_dot2c_f32_bf16 v35, v121, v8
    v_dot2c_f32_bf16 v36, v122, v7
    v_dot2c_f32_bf16 v37, v122, v8
    v_dot2c_f32_bf16 v38, v123, v7
    v_dot2c_f32_bf16 v39, v123, v8
    buffer_load_dwordx4 v[136:139], v4, s[8:11], s48 offen offset:0 nt
    buffer_load_dwordx4 v[140:143], v4, s[8:11], s48 offen offset:128 nt
    buffer_load_dwordx4 v[144:147], v4, s[8:11], s48 offen offset:256 nt
    s_add_u32 s48, s48, 3072
    s_waitcnt vmcnt(1)
    v_cvt_pk_bf16_f32 v7, v54, 0
    v_cvt_pk_bf16_f32 v8, 0, v54
    v_dot2c_f32_bf16 v16, v124, v7
    v_dot2c_f32_bf16 v17, v124, v8
    v_dot2c_f32_bf16 v18, v125, v7
    v_dot2c_f32_bf16 v19, v125, v8
    v_dot2c_f32_bf16 v20, v126, v7
    v_dot2c_f32_bf16 v21, v126, v8
    v_dot2c_f32_bf16 v22, v127, v7
    v_dot2c_f32_bf16 v23, v127, v8
    v_dot2c_f32_bf16 v24, v128, v7
    v_dot2c_f32_bf16 v25, v128, v8
    v_dot2c_f32_bf16 v26, v129, v7
    v_dot2c_f32_bf16 v27, v129, v8
    v_dot2c_f32_bf16 v28, v130, v7
    v_dot2c_f32_bf16 v29, v130, v8
    v_dot2c_f32_bf16 v30, v131, v7
    v_dot2c_f32_bf16 v31, v131, v8
    v_dot2c_f32_bf16 v32, v132, v7
    v_dot2c_f32_bf16 v33, v132, v8
    v_dot2c_f32_bf16 v34, v133, v7
    v_dot2c_f32_bf16 v35, v133, v8
    v_dot2c_f32_bf16 v36, v134, v7
    v_dot2c_f32_bf16 v37, v134, v8
    v_dot2c_f32_bf16 v38, v135, v7
    v_dot2c_f32_bf16 v39, v135, v8
    buffer_load_dwordx4 v[148:151], v4, s[8:11], s48 offen offset:0 nt
    buffer_load_dwordx4 v[152:155], v4, s[8:11], s48 offen offset:128 nt
    buffer_load_dwordx4 v[156:159], v4, s[8:11], s48 offen offset:256 nt
    s_add_u32 s48, s48, 3072
    s_waitcnt vmcnt(1)
    v_cvt_pk_bf16_f32 v7, v55, 0
    v_cvt_pk_bf16_f32 v8, 0, v55
    v_dot2c_f32_bf16 v16, v136, v7
    v_dot2c_f32_bf16 v17, v136, v8
    v_dot2c_f32_bf16 v18, v137, v7
    v_dot2c_f32_bf16 v19, v137, v8
    v_dot2c_f32_bf16 v20, v138, v7
    v_dot2c_f32_bf16 v21, v138, v8
    v_dot2c_f32_bf16 v22, v139, v7
    v_dot2c_f32_bf16 v23, v139, v8
    v_dot2c_f32_bf16 v24, v140, v7
    v_dot2c_f32_bf16 v25, v140, v8
    v_dot2c_f32_bf16 v26, v141, v7
    v_dot2c_f32_bf16 v27, v141, v8
    v_dot2c_f32_bf16 v28, v142, v7
    v_dot2c_f32_bf16 v29, v142, v8
    v_dot2c_f32_bf16 v30, v143, v7
    v_dot2c_f32_bf16 v31, v143, v8
    v_dot2c_f32_bf16 v32, v144, v7
    v_dot2c_f32_bf16 v33, v144, v8
    v_dot2c_f32_bf16 v34, v145, v7
    v_dot2c_f32_bf16 v35, v145, v8
    v_dot2c_f32_bf16 v36, v146, v7
    v_dot2c_f32_bf16 v37, v146, v8
    v_dot2c_f32_bf16 v38, v147, v7
    v_dot2c_f32_bf16 v39, v147, v8
    buffer_load_dwordx4 v[160:163], v4, s[8:11], s48 offen offset:0 nt
    buffer_load_dwordx4 v[164:167], v4, s[8:11], s48 offen offset:128 nt
    buffer_load_dwordx4 v[168:171], v4, s[8:11], s48 offen offset:256 nt
    s_add_u32 s48, s48, 3072
    s_waitcnt vmcnt(1)
    v_cvt_pk_bf16_f32 v7, v56, 0
    v_cvt_pk_bf16_f32 v8, 0, v56
    v_dot2c_f32_bf16 v16, v148, v7
    v_dot2c_f32_bf16 v17, v148, v8
    v_dot2c_f32_bf16 v18, v149, v7
    v_dot2c_f32_bf16 v19, v149, v8
    v_dot2c_f32_bf16 v20, v150, v7
    v_dot2c_f32_bf16 v21, v150, v8
    v_dot2c_f32_bf16 v22, v151, v7
    v_dot2c_f32_bf16 v23, v151, v8
    v_dot2c_f32_bf16 v24, v152, v7
    v_dot2c_f32_bf16 v25, v152, v8
    v_dot2c_f32_bf16 v26, v153, v7
    v_dot2c_f32_bf16 v27, v153, v8
    v_dot2c_f32_bf16 v28, v154, v7
    v_dot2c_f32_bf16 v29, v154, v8
    v_dot2c_f32_bf16 v30, v155, v7
    v_dot2c_f32_bf16 v31, v155, v8
    v_dot2c_f32_bf16 v32, v156, v7
    v_dot2c_f32_bf16 v33, v156, v8
    v_dot2c_f32_bf16 v34, v157, v7
    v_dot2c_f32_bf16 v35, v157, v8
    v_dot2c_f32_bf16 v36, v158, v7
    v_dot2c_f32_bf16 v37, v158, v8
    v_dot2c_f32_bf16 v38, v159, v7
    v_dot2c_f32_bf16 v39, v159, v8
    buffer_load_dwordx4 v[172:175], v4, s[8:11], s48 offen offset:0 nt
    buffer_load_dwordx4 v[176:179], v4, s[8:11], s48 offen offset:128 nt
    buffer_load_dwordx4 v[180:183], v4, s[8:11], s48 offen offset:256 nt
    s_add_u32 s48, s48, 3072
    s_waitcnt vmcnt(1)
    v_cvt_pk_bf16_f32 v7, v57, 0
    v_cvt_pk_bf16_f32 v8, 0, v57
    v_dot2c_f32_bf16 v16, v160, v7
    v_dot2c_f32_bf16 v17, v160, v8
    v_dot2c_f32_bf16 v18, v161, v7
    v_dot2c_f32_bf16 v19, v161, v8
    v_dot2c_f32_bf16 v20, v162, v7
    v_dot2c_f32_bf16 v21, v162, v8
    v_dot2c_f32_bf16 v22, v163, v7
    v_dot2c_f32_bf16 v23, v163, v8
    v_dot2c_f32_bf16 v24, v164, v7
    v_dot2c_f32_bf16 v25, v164, v8
    v_dot2c_f32_bf16 v26, v165, v7
    v_dot2c_f32_bf16 v27, v165, v8
    v_dot2c_f32_bf16 v28, v166, v7
    v_dot2c_f32_bf16 v29, v166, v8
    v_dot2c_f32_bf16 v30, v167, v7
    v_dot2c_f32_bf16 v31, v167, v8
    v_dot2c_f32_bf16 v32, v168, v7
    v_dot2c_f32_bf16 v33, v168, v8
    v_dot2c_f32_bf16 v34, v169, v7
    v_dot2c_f32_bf16 v35, v169, v8
    v_dot2c_f32_bf16 v36, v170, v7
    v_dot2c_f32_bf16 v37, v170, v8
    v_dot2c_f32_bf16 v38, v171, v7
    v_dot2c_f32_bf16 v39, v171, v8
    buffer_load_dwordx4 v[184:187], v4, s[8:11], s48 offen offset:0 nt
    buffer_load_dwordx4 v[188:191], v4, s[8:11], s48 offen offset:128 nt
    buffer_load_dwordx4 v[192:195], v4, s[8:11], s48 offen offset:256 nt
    s_add_u32 s48, s48, 3072
    s_waitcnt vmcnt(1)
    v_cvt_pk_bf16_f32 v7, v58, 0
    v_cvt_pk_bf16_f32 v8, 0, v58
    v_dot2c_f32_bf16 v16, v172, v7
    v_dot2c_f32_bf16 v17, v172, v8
    v_dot2c_f32_bf16 v18, v173, v7
    v_dot2c_f32_bf16 v19, v173, v8
    v_dot2c_f32_bf16 v20, v174, v7
    v_dot2c_f32_bf16 v21, v174, v8
    v_dot2c_f32_bf16 v22, v175, v7
    v_dot2c_f32_bf16 v23, v175, v8
    v_dot2c_f32_bf16 v24, v176, v7
    v_dot2c_f32_bf16 v25, v176, v8
    v_dot2c_f32_bf16 v26, v177, v7
    v_dot2c_f32_bf16 v27, v177, v8
    v_dot2c_f32_bf16 v28, v178, v7
    v_dot2c_f32_bf16 v29, v178, v8
    v_dot2c_f32_bf16 v30, v179, v7
    v_dot2c_f32_bf16 v31, v179, v8
    v_dot2c_f32_bf16 v32, v180, v7
    v_dot2c_f32_bf16 v33, v180, v8
    v_dot2c_f32_bf16 v34, v181, v7
    v_dot2c_f32_bf16 v35, v181, v8
    v_dot2c_f32_bf16 v36, v182, v7
    v_dot2c_f32_bf16 v37, v182, v8
    v_dot2c_f32_bf16 v38, v183, v7
    v_dot2c_f32_bf16 v39, v183, v8
    s_add_u32 s48, s99, 1
    s_and_b32 s48, s48, 3
    s_mul_i32 s48, s48, 196608
    s_add_u32 s48, s48, s49
    buffer_load_dwordx4 v[196:199], v4, s[8:11], s48 offen offset:0 nt
    buffer_load_dwordx4 v[200:203], v4, s[8:11], s48 offen offset:128 nt
    buffer_load_dwordx4 v[204:207], v4, s[8:11], s48 offen offset:256 nt
    s_add_u32 s48, s48, 3072
    s_waitcnt vmcnt(1)
    v_cvt_pk_bf16_f32 v7, v59, 0
    v_cvt_pk_bf16_f32 v8, 0, v59
    v_dot2c_f32_bf16 v16, v184, v7
    v_dot2c_f32_bf16 v17, v184, v8
    v_dot2c_f32_bf16 v18, v185, v7
    v_dot2c_f32_bf16 v19, v185, v8
    v_dot2c_f32_bf16 v20, v186, v7
    v_dot2c_f32_bf16 v21, v186, v8
    v_dot2c_f32_bf16 v22, v187, v7
    v_dot2c_f32_bf16 v23, v187, v8
    v_dot2c_f32_bf16 v24, v188, v7
    v_dot2c_f32_bf16 v25, v188, v8
    v_dot2c_f32_bf16 v26, v189, v7
    v_dot2c_f32_bf16 v27, v189, v8
    v_dot2c_f32_bf16 v28, v190, v7
    v_dot2c_f32_bf16 v29, v190, v8
    v_dot2c_f32_bf16 v30, v191, v7
    v_dot2c_f32_bf16 v31, v191, v8
    v_dot2c_f32_bf16 v32, v192, v7
    v_dot2c_f32_bf16 v33, v192, v8
    v_dot2c_f32_bf16 v34, v193, v7
    v_dot2c_f32_bf16 v35, v193, v8
    v_dot2c_f32_bf16 v36, v194, v7
    v_dot2c_f32_bf16 v37, v194, v8
    v_dot2c_f32_bf16 v38, v195, v7
    v_dot2c_f32_bf16 v39, v195, v8
    buffer_load_dwordx4 v[208:211], v4, s[8:11], s48 offen offset:0 nt
    buffer_load_dwordx4 v[212:215], v4, s[8:11], s48 offen offset:128 nt
    buffer_load_dwordx4 v[216:219], v4, s[8:11], s48 offen offset:256 nt
    s_add_u32 s48, s48, 3072
    s_waitcnt vmcnt(1)
    v_cvt_pk_bf16_f32 v7, v60, 0
    v_cvt_pk_bf16_f32 v8, 0, v60
    v_dot2c_f32_bf16 v16, v196, v7
    v_dot2c_f32_bf16 v17, v196, v8
    v_dot2c_f32_bf16 v18, v197, v7
    v_dot2c_f32_bf16 v19, v197, v8
    v_dot2c_f32_bf16 v20, v198, v7
    v_dot2c_f32_bf16 v21, v198, v8
    v_dot2c_f32_bf16 v22, v199, v7
    v_dot2c_f32_bf16 v23, v199, v8
    v_dot2c_f32_bf16 v24, v200, v7
    v_dot2c_f32_bf16 v25, v200, v8
    v_dot2c_f32_bf16 v26, v201, v7
    v_dot2c_f32_bf16 v27, v201, v8
    v_dot2c_f32_bf16 v28, v202, v7
    v_dot2c_f32_bf16 v29, v202, v8
    v_dot2c_f32_bf16 v30, v203, v7
    v_dot2c_f32_bf16 v31, v203, v8
    v_dot2c_f32_bf16 v32, v204, v7
    v_dot2c_f32_bf16 v33, v204, v8
    v_dot2c_f32_bf16 v34, v205, v7
    v_dot2c_f32_bf16 v35, v205, v8
    v_dot2c_f32_bf16 v36, v206, v7
    v_dot2c_f32_bf16 v37, v206, v8
    v_dot2c_f32_bf16 v38, v207, v7
    v_dot2c_f32_bf16 v39, v207, v8
    buffer_load_dwordx4 v[224:227], v4, s[8:11], s48 offen offset:0 nt
    buffer_load_dwordx4 v[228:231], v4, s[8:11], s48 offen offset:128 nt
    buffer_load_dwordx4 v[232:235], v4, s[8:11], s48 offen offset:256 nt
    s_add_u32 s48, s48, 3072
    s_waitcnt vmcnt(1)
    v_cvt_pk_bf16_f32 v7, v61, 0
    v_cvt_pk_bf16_f32 v8, 0, v61
    v_dot2c_f32_bf16 v16, v208, v7
    v_dot2c_f32_bf16 v17, v208, v8
    v_dot2c_f32_bf16 v18, v209, v7
    v_dot2c_f32_bf16 v19, v209, v8
    v_dot2c_f32_bf16 v20, v210, v7
    v_dot2c_f32_bf16 v21, v210, v8
    v_dot2c_f32_bf16 v22, v211, v7
    v_dot2c_f32_bf16 v23, v211, v8
    v_dot2c_f32_bf16 v24, v212, v7
    v_dot2c_f32_bf16 v25, v212, v8
    v_dot2c_f32_bf16 v26, v213, v7
    v_dot2c_f32_bf16 v27, v213, v8
    v_dot2c_f32_bf16 v28, v214, v7
    v_dot2c_f32_bf16 v29, v214, v8
    v_dot2c_f32_bf16 v30, v215, v7
    v_dot2c_f32_bf16 v31, v215, v8
    v_dot2c_f32_bf16 v32, v216, v7
    v_dot2c_f32_bf16 v33, v216, v8
    v_dot2c_f32_bf16 v34, v217, v7
    v_dot2c_f32_bf16 v35, v217, v8
    v_dot2c_f32_bf16 v36, v218, v7
    v_dot2c_f32_bf16 v37, v218, v8
    v_dot2c_f32_bf16 v38, v219, v7
    v_dot2c_f32_bf16 v39, v219, v8
    buffer_load_dwordx4 v[236:239], v4, s[8:11], s48 offen offset:0 nt
    buffer_load_dwordx4 v[240:243], v4, s[8:11], s48 offen offset:128 nt
    buffer_load_dwordx4 v[244:247], v4, s[8:11], s48 offen offset:256 nt
    s_add_u32 s48, s48, 3072
    s_waitcnt vmcnt(1)
    v_cvt_pk_bf16_f32 v7, v62, 0
    v_cvt_pk_bf16_f32 v8, 0, v62
    v_dot2c_f32_bf16 v16, v224, v7
    v_dot2c_f32_bf16 v17, v224, v8
    v_dot2c_f32_bf16 v18, v225, v7
    v_dot2c_f32_bf16 v19, v225, v8
    v_dot2c_f32_bf16 v20, v226, v7
    v_dot2c_f32_bf16 v21, v226, v8
    v_dot2c_f32_bf16 v22, v227, v7
    v_dot2c_f32_bf16 v23, v227, v8
    v_dot2c_f32_bf16 v24, v228, v7
    v_dot2c_f32_bf16 v25, v228, v8
    v_dot2c_f32_bf16 v26, v229, v7
    v_dot2c_f32_bf16 v27, v229, v8
    v_dot2c_f32_bf16 v28, v230, v7
    v_dot2c_f32_bf16 v29, v230, v8
    v_dot2c_f32_bf16 v30, v231, v7
    v_dot2c_f32_bf16 v31, v231, v8
    v_dot2c_f32_bf16 v32, v232, v7
    v_dot2c_f32_bf16 v33, v232, v8
    v_dot2c_f32_bf16 v34, v233, v7
    v_dot2c_f32_bf16 v35, v233, v8
    v_dot2c_f32_bf16 v36, v234, v7
    v_dot2c_f32_bf16 v37, v234, v8
    v_dot2c_f32_bf16 v38, v235, v7
    v_dot2c_f32_bf16 v39, v235, v8
    buffer_load_dwordx4 v[112:115], v4, s[8:11], s48 offen offset:0 nt
    buffer_load_dwordx4 v[116:119], v4, s[8:11], s48 offen offset:128 nt
    buffer_load_dwordx4 v[120:123], v4, s[8:11], s48 offen offset:256 nt
    s_add_u32 s48, s48, 3072
    s_waitcnt vmcnt(1)
    v_cvt_pk_bf16_f32 v7, v63, 0
    v_cvt_pk_bf16_f32 v8, 0, v63
    v_dot2c_f32_bf16 v16, v236, v7
    v_dot2c_f32_bf16 v17, v236, v8
    v_dot2c_f32_bf16 v18, v237, v7
    v_dot2c_f32_bf16 v19, v237, v8
    v_dot2c_f32_bf16 v20, v238, v7
    v_dot2c_f32_bf16 v21, v238, v8
    v_dot2c_f32_bf16 v22, v239, v7
    v_dot2c_f32_bf16 v23, v239, v8
    v_dot2c_f32_bf16 v24, v240, v7
    v_dot2c_f32_bf16 v25, v240, v8
    v_dot2c_f32_bf16 v26, v241, v7
    v_dot2c_f32_bf16 v27, v241, v8
    v_dot2c_f32_bf16 v28, v242, v7
    v_dot2c_f32_bf16 v29, v242, v8
    v_dot2c_f32_bf16 v30, v243, v7
    v_dot2c_f32_bf16 v31, v243, v8
    v_dot2c_f32_bf16 v32, v244, v7
    v_dot2c_f32_bf16 v33, v244, v8
    v_dot2c_f32_bf16 v34, v245, v7
    v_dot2c_f32_bf16 v35, v245, v8
    v_dot2c_f32_bf16 v36, v246, v7
    v_dot2c_f32_bf16 v37, v246, v8
    v_dot2c_f32_bf16 v38, v247, v7
    v_dot2c_f32_bf16 v39, v247, v8
    buffer_load_dwordx4 v[124:127], v4, s[8:11], s48 offen offset:0 nt
    buffer_load_dwordx4 v[128:131], v4, s[8:11], s48 offen offset:128 nt
    buffer_load_dwordx4 v[132:135], v4, s[8:11], s48 offen offset:256 nt
    s_add_u32 s48, s48, 3072
    s_waitcnt vmcnt(1)
    v_cvt_pk_bf16_f32 v7, v64, 0
    v_cvt_pk_bf16_f32 v8, 0, v64
    v_dot2c_f32_bf16 v16, v112, v7
    v_dot2c_f32_bf16 v17, v112, v8
    v_dot2c_f32_bf16 v18, v113, v7
    v_dot2c_f32_bf16 v19, v113, v8
    v_dot2c_f32_bf16 v20, v114, v7
    v_dot2c_f32_bf16 v21, v114, v8
    v_dot2c_f32_bf16 v22, v115, v7
    v_dot2c_f32_bf16 v23, v115, v8
    v_dot2c_f32_bf16 v24, v116, v7
    v_dot2c_f32_bf16 v25, v116, v8
    v_dot2c_f32_bf16 v26, v117, v7
    v_dot2c_f32_bf16 v27, v117, v8
    v_dot2c_f32_bf16 v28, v118, v7
    v_dot2c_f32_bf16 v29, v118, v8
    v_dot2c_f32_bf16 v30, v119, v7
    v_dot2c_f32_bf16 v31, v119, v8
    v_dot2c_f32_bf16 v32, v120, v7
    v_dot2c_f32_bf16 v33, v120, v8
    v_dot2c_f32_bf16 v34, v121, v7
    v_dot2c_f32_bf16 v35, v121, v8
    v_dot2c_f32_bf16 v36, v122, v7
    v_dot2c_f32_bf16 v37, v122, v8
    v_dot2c_f32_bf16 v38, v123, v7
    v_dot2c_f32_bf16 v39, v123, v8
    buffer_load_dwordx4 v[136:139], v4, s[8:11], s48 offen offset:0 nt
    buffer_load_dwordx4 v[140:143], v4, s[8:11], s48 offen offset:128 nt
    buffer_load_dwordx4 v[144:147], v4, s[8:11], s48 offen offset:256 nt
    s_add_u32 s48, s48, 3072
    s_waitcnt vmcnt(1)
    v_cvt_pk_bf16_f32 v7, v65, 0
    v_cvt_pk_bf16_f32 v8, 0, v65
    v_dot2c_f32_bf16 v16, v124, v7
    v_dot2c_f32_bf16 v17, v124, v8
    v_dot2c_f32_bf16 v18, v125, v7
    v_dot2c_f32_bf16 v19, v125, v8
    v_dot2c_f32_bf16 v20, v126, v7
    v_dot2c_f32_bf16 v21, v126, v8
    v_dot2c_f32_bf16 v22, v127, v7
    v_dot2c_f32_bf16 v23, v127, v8
    v_dot2c_f32_bf16 v24, v128, v7
    v_dot2c_f32_bf16 v25, v128, v8
    v_dot2c_f32_bf16 v26, v129, v7
    v_dot2c_f32_bf16 v27, v129, v8
    v_dot2c_f32_bf16 v28, v130, v7
    v_dot2c_f32_bf16 v29, v130, v8
    v_dot2c_f32_bf16 v30, v131, v7
    v_dot2c_f32_bf16 v31, v131, v8
    v_dot2c_f32_bf16 v32, v132, v7
    v_dot2c_f32_bf16 v33, v132, v8
    v_dot2c_f32_bf16 v34, v133, v7
    v_dot2c_f32_bf16 v35, v133, v8
    v_dot2c_f32_bf16 v36, v134, v7
    v_dot2c_f32_bf16 v37, v134, v8
    v_dot2c_f32_bf16 v38, v135, v7
    v_dot2c_f32_bf16 v39, v135, v8
    buffer_load_dwordx4 v[148:151], v4, s[8:11], s48 offen offset:0 nt
    buffer_load_dwordx4 v[152:155], v4, s[8:11], s48 offen offset:128 nt
    buffer_load_dwordx4 v[156:159], v4, s[8:11], s48 offen offset:256 nt
    s_add_u32 s48, s48, 3072
    s_waitcnt vmcnt(1)
    v_cvt_pk_bf16_f32 v7, v66, 0
    v_cvt_pk_bf16_f32 v8, 0, v66
    v_dot2c_f32_bf16 v16, v136, v7
    v_dot2c_f32_bf16 v17, v136, v8
    v_dot2c_f32_bf16 v18, v137, v7
    v_dot2c_f32_bf16 v19, v137, v8
    v_dot2c_f32_bf16 v20, v138, v7
    v_dot2c_f32_bf16 v21, v138, v8
    v_dot2c_f32_bf16 v22, v139, v7
    v_dot2c_f32_bf16 v23, v139, v8
    v_dot2c_f32_bf16 v24, v140, v7
    v_dot2c_f32_bf16 v25, v140, v8
    v_dot2c_f32_bf16 v26, v141, v7
    v_dot2c_f32_bf16 v27, v141, v8
    v_dot2c_f32_bf16 v28, v142, v7
    v_dot2c_f32_bf16 v29, v142, v8
    v_dot2c_f32_bf16 v30, v143, v7
    v_dot2c_f32_bf16 v31, v143, v8
    v_dot2c_f32_bf16 v32, v144, v7
    v_dot2c_f32_bf16 v33, v144, v8
    v_dot2c_f32_bf16 v34, v145, v7
    v_dot2c_f32_bf16 v35, v145, v8
    v_dot2c_f32_bf16 v36, v146, v7
    v_dot2c_f32_bf16 v37, v146, v8
    v_dot2c_f32_bf16 v38, v147, v7
    v_dot2c_f32_bf16 v39, v147, v8
    s_add_u32 s48, s99, 2
    s_and_b32 s48, s48, 3
    s_mul_i32 s48, s48, 196608
    s_add_u32 s48, s48, s49
    buffer_load_dwordx4 v[160:163], v4, s[8:11], s48 offen offset:0 nt
    buffer_load_dwordx4 v[164:167], v4, s[8:11], s48 offen offset:128 nt
    buffer_load_dwordx4 v[168:171], v4, s[8:11], s48 offen offset:256 nt
    s_add_u32 s48, s48, 3072
    s_waitcnt vmcnt(1)
    v_cvt_pk_bf16_f32 v7, v67, 0
    v_cvt_pk_bf16_f32 v8, 0, v67
    v_dot2c_f32_bf16 v16, v148, v7
    v_dot2c_f32_bf16 v17, v148, v8
    v_dot2c_f32_bf16 v18, v149, v7
    v_dot2c_f32_bf16 v19, v149, v8
    v_dot2c_f32_bf16 v20, v150, v7
    v_dot2c_f32_bf16 v21, v150, v8
    v_dot2c_f32_bf16 v22, v151, v7
    v_dot2c_f32_bf16 v23, v151, v8
    v_dot2c_f32_bf16 v24, v152, v7
    v_dot2c_f32_bf16 v25, v152, v8
    v_dot2c_f32_bf16 v26, v153, v7
    v_dot2c_f32_bf16 v27, v153, v8
    v_dot2c_f32_bf16 v28, v154, v7
    v_dot2c_f32_bf16 v29, v154, v8
    v_dot2c_f32_bf16 v30, v155, v7
    v_dot2c_f32_bf16 v31, v155, v8
    v_dot2c_f32_bf16 v32, v156, v7
    v_dot2c_f32_bf16 v33, v156, v8
    v_dot2c_f32_bf16 v34, v157, v7
    v_dot2c_f32_bf16 v35, v157, v8
    v_dot2c_f32_bf16 v36, v158, v7
    v_dot2c_f32_bf16 v37, v158, v8
    v_dot2c_f32_bf16 v38, v159, v7
    v_dot2c_f32_bf16 v39, v159, v8
    buffer_load_dwordx4 v[172:175], v4, s[8:11], s48 offen offset:0 nt
    buffer_load_dwordx4 v[176:179], v4, s[8:11], s48 offen offset:128 nt
    buffer_load_dwordx4 v[180:183], v4, s[8:11], s48 offen offset:256 nt
    s_add_u32 s48, s48, 3072
    s_waitcnt vmcnt(1)
    v_cvt_pk_bf16_f32 v7, v68, 0
    v_cvt_pk_bf16_f32 v8, 0, v68
    v_dot2c_f32_bf16 v16, v160, v7
    v_dot2c_f32_bf16 v17, v160, v8
    v_dot2c_f32_bf16 v18, v161, v7
    v_dot2c_f32_bf16 v19, v161, v8
    v_dot2c_f32_bf16 v20, v162, v7
    v_dot2c_f32_bf16 v21, v162, v8
    v_dot2c_f32_bf16 v22, v163, v7
    v_dot2c_f32_bf16 v23, v163, v8
    v_dot2c_f32_bf16 v24, v164, v7
    v_dot2c_f32_bf16 v25, v164, v8
    v_dot2c_f32_bf16 v26, v165, v7
    v_dot2c_f32_bf16 v27, v165, v8
    v_dot2c_f32_bf16 v28, v166, v7
    v_dot2c_f32_bf16 v29, v166, v8
    v_dot2c_f32_bf16 v30, v167, v7
    v_dot2c_f32_bf16 v31, v167, v8
    v_dot2c_f32_bf16 v32, v168, v7
    v_dot2c_f32_bf16 v33, v168, v8
    v_dot2c_f32_bf16 v34, v169, v7
    v_dot2c_f32_bf16 v35, v169, v8
    v_dot2c_f32_bf16 v36, v170, v7
    v_dot2c_f32_bf16 v37, v170, v8
    v_dot2c_f32_bf16 v38, v171, v7
    v_dot2c_f32_bf16 v39, v171, v8
    buffer_load_dwordx4 v[184:187], v4, s[8:11], s48 offen offset:0 nt
    buffer_load_dwordx4 v[188:191], v4, s[8:11], s48 offen offset:128 nt
    buffer_load_dwordx4 v[192:195], v4, s[8:11], s48 offen offset:256 nt
    s_add_u32 s48, s48, 3072
    s_waitcnt vmcnt(1)
    v_cvt_pk_bf16_f32 v7, v69, 0
    v_cvt_pk_bf16_f32 v8, 0, v69
    v_dot2c_f32_bf16 v16, v172, v7
    v_dot2c_f32_bf16 v17, v172, v8
    v_dot2c_f32_bf16 v18, v173, v7
    v_dot2c_f32_bf16 v19, v173, v8
    v_dot2c_f32_bf16 v20, v174, v7
    v_dot2c_f32_bf16 v21, v174, v8
    v_dot2c_f32_bf16 v22, v175, v7
    v_dot2c_f32_bf16 v23, v175, v8
    v_dot2c_f32_bf16 v24, v176, v7
    v_dot2c_f32_bf16 v25, v176, v8
    v_dot2c_f32_bf16 v26, v177, v7
    v_dot2c_f32_bf16 v27, v177, v8
    v_dot2c_f32_bf16 v28, v178, v7
    v_dot2c_f32_bf16 v29, v178, v8
    v_dot2c_f32_bf16 v30, v179, v7
    v_dot2c_f32_bf16 v31, v179, v8
    v_dot2c_f32_bf16 v32, v180, v7
    v_dot2c_f32_bf16 v33, v180, v8
    v_dot2c_f32_bf16 v34, v181, v7
    v_dot2c_f32_bf16 v35, v181, v8
    v_dot2c_f32_bf16 v36, v182, v7
    v_dot2c_f32_bf16 v37, v182, v8
    v_dot2c_f32_bf16 v38, v183, v7
    v_dot2c_f32_bf16 v39, v183, v8
    buffer_load_dwordx4 v[196:199], v4, s[8:11], s48 offen offset:0 nt
    buffer_load_dwordx4 v[200:203], v4, s[8:11], s48 offen offset:128 nt
    buffer_load_dwordx4 v[204:207], v4, s[8:11], s48 offen offset:256 nt
    s_add_u32 s48, s48, 3072
    s_waitcnt vmcnt(1)
    v_cvt_pk_bf16_f32 v7, v70, 0
    v_cvt_pk_bf16_f32 v8, 0, v70
    v_dot2c_f32_bf16 v16, v184, v7
    v_dot2c_f32_bf16 v17, v184, v8
    v_dot2c_f32_bf16 v18, v185, v7
    v_dot2c_f32_bf16 v19, v185, v8
    v_dot2c_f32_bf16 v20, v186, v7
    v_dot2c_f32_bf16 v21, v186, v8
    v_dot2c_f32_bf16 v22, v187, v7
    v_dot2c_f32_bf16 v23, v187, v8
    v_dot2c_f32_bf16 v24, v188, v7
    v_dot2c_f32_bf16 v25, v188, v8
    v_dot2c_f32_bf16 v26, v189, v7
    v_dot2c_f32_bf16 v27, v189, v8
    v_dot2c_f32_bf16 v28, v190, v7
    v_dot2c_f32_bf16 v29, v190, v8
    v_dot2c_f32_bf16 v30, v191, v7
    v_dot2c_f32_bf16 v31, v191, v8
    v_dot2c_f32_bf16 v32, v192, v7
    v_dot2c_f32_bf16 v33, v192, v8
    v_dot2c_f32_bf16 v34, v193, v7
    v_dot2c_f32_bf16 v35, v193, v8
    v_dot2c_f32_bf16 v36, v194, v7
    v_dot2c_f32_bf16 v37, v194, v8
    v_dot2c_f32_bf16 v38, v195, v7
    v_dot2c_f32_bf16 v39, v195, v8
    buffer_load_dwordx4 v[208:211], v4, s[8:11], s48 offen offset:0 nt
    buffer_load_dwordx4 v[212:215], v4, s[8:11], s48 offen offset:128 nt
    buffer_load_dwordx4 v[216:219], v4, s[8:11], s48 offen offset:256 nt
    s_add_u32 s48, s48, 3072
    s_waitcnt vmcnt(1)
    v_cvt_pk_bf16_f32 v7, v71, 0
    v_cvt_pk_bf16_f32 v8, 0, v71
    v_dot2c_f32_bf16 v16, v196, v7
    v_dot2c_f32_bf16 v17, v196, v8
    v_dot2c_f32_bf16 v18, v197, v7
    v_dot2c_f32_bf16 v19, v197, v8
    v_dot2c_f32_bf16 v20, v198, v7
    v_dot2c_f32_bf16 v21, v198, v8
    v_dot2c_f32_bf16 v22, v199, v7
    v_dot2c_f32_bf16 v23, v199, v8
    v_dot2c_f32_bf16 v24, v200, v7
    v_dot2c_f32_bf16 v25, v200, v8
    v_dot2c_f32_bf16 v26, v201, v7
    v_dot2c_f32_bf16 v27, v201, v8
    v_dot2c_f32_bf16 v28, v202, v7
    v_dot2c_f32_bf16 v29, v202, v8
    v_dot2c_f32_bf16 v30, v203, v7
    v_dot2c_f32_bf16 v31, v203, v8
    v_dot2c_f32_bf16 v32, v204, v7
    v_dot2c_f32_bf16 v33, v204, v8
    v_dot2c_f32_bf16 v34, v205, v7
    v_dot2c_f32_bf16 v35, v205, v8
    v_dot2c_f32_bf16 v36, v206, v7
    v_dot2c_f32_bf16 v37, v206, v8
    v_dot2c_f32_bf16 v38, v207, v7
    v_dot2c_f32_bf16 v39, v207, v8
    buffer_load_dwordx4 v[224:227], v4, s[8:11], s48 offen offset:0 nt
    buffer_load_dwordx4 v[228:231], v4, s[8:11], s48 offen offset:128 nt
    buffer_load_dwordx4 v[232:235], v4, s[8:11], s48 offen offset:256 nt
    s_add_u32 s48, s48, 3072
    s_waitcnt vmcnt(1)
    v_cvt_pk_bf16_f32 v7, v72, 0
    v_cvt_pk_bf16_f32 v8, 0, v72
    v_dot2c_f32_bf16 v16, v208, v7
    v_dot2c_f32_bf16 v17, v208, v8
    v_dot2c_f32_bf16 v18, v209, v7
    v_dot2c_f32_bf16 v19, v209, v8
    v_dot2c_f32_bf16 v20, v210, v7
    v_dot2c_f32_bf16 v21, v210, v8
    v_dot2c_f32_bf16 v22, v211, v7
    v_dot2c_f32_bf16 v23, v211, v8
    v_dot2c_f32_bf16 v24, v212, v7
    v_dot2c_f32_bf16 v25, v212, v8
    v_dot2c_f32_bf16 v26, v213, v7
    v_dot2c_f32_bf16 v27, v213, v8
    v_dot2c_f32_bf16 v28, v214, v7
    v_dot2c_f32_bf16 v29, v214, v8
    v_dot2c_f32_bf16 v30, v215, v7
    v_dot2c_f32_bf16 v31, v215, v8
    v_dot2c_f32_bf16 v32, v216, v7
    v_dot2c_f32_bf16 v33, v216, v8
    v_dot2c_f32_bf16 v34, v217, v7
    v_dot2c_f32_bf16 v35, v217, v8
    v_dot2c_f32_bf16 v36, v218, v7
    v_dot2c_f32_bf16 v37, v218, v8
    v_dot2c_f32_bf16 v38, v219, v7
    v_dot2c_f32_bf16 v39, v219, v8
    buffer_load_dwordx4 v[236:239], v4, s[8:11], s48 offen offset:0 nt
    buffer_load_dwordx4 v[240:243], v4, s[8:11], s48 offen offset:128 nt
    buffer_load_dwordx4 v[244:247], v4, s[8:11], s48 offen offset:256 nt
    s_add_u32 s48, s48, 3072
    s_waitcnt vmcnt(1)
    v_cvt_pk_bf16_f32 v7, v73, 0
    v_cvt_pk_bf16_f32 v8, 0, v73
    v_dot2c_f32_bf16 v16, v224, v7
    v_dot2c_f32_bf16 v17, v224, v8
    v_dot2c_f32_bf16 v18, v225, v7
    v_dot2c_f32_bf16 v19, v225, v8
    v_dot2c_f32_bf16 v20, v226, v7
    v_dot2c_f32_bf16 v21, v226, v8
    v_dot2c_f32_bf16 v22, v227, v7
    v_dot2c_f32_bf16 v23, v227, v8
    v_dot2c_f32_bf16 v24, v228, v7
    v_dot2c_f32_bf16 v25, v228, v8
    v_dot2c_f32_bf16 v26, v229, v7
    v_dot2c_f32_bf16 v27, v229, v8
    v_dot2c_f32_bf16 v28, v230, v7
    v_dot2c_f32_bf16 v29, v230, v8
    v_dot2c_f32_bf16 v30, v231, v7
    v_dot2c_f32_bf16 v31, v231, v8
    v_dot2c_f32_bf16 v32, v232, v7
    v_dot2c_f32_bf16 v33, v232, v8
    v_dot2c_f32_bf16 v34, v233, v7
    v_dot2c_f32_bf16 v35, v233, v8
    v_dot2c_f32_bf16 v36, v234, v7
    v_dot2c_f32_bf16 v37, v234, v8
    v_dot2c_f32_bf16 v38, v235, v7
    v_dot2c_f32_bf16 v39, v235, v8
    buffer_load_dwordx4 v[112:115], v4, s[8:11], s48 offen offset:0 nt
    buffer_load_dwordx4 v[116:119], v4, s[8:11], s48 offen offset:128 nt
    buffer_load_dwordx4 v[120:123], v4, s[8:11], s48 offen offset:256 nt
    s_add_u32 s48, s48, 3072
    s_waitcnt vmcnt(1)
    v_cvt_pk_bf16_f32 v7, v74, 0
    v_cvt_pk_bf16_f32 v8, 0, v74
    v_dot2c_f32_bf16 v16, v236, v7
    v_dot2c_f32_bf16 v17, v236, v8
    v_dot2c_f32_bf16 v18, v237, v7
    v_dot2c_f32_bf16 v19, v237, v8
    v_dot2c_f32_bf16 v20, v238, v7
    v_dot2c_f32_bf16 v21, v238, v8
    v_dot2c_f32_bf16 v22, v239, v7
    v_dot2c_f32_bf16 v23, v239, v8
    v_dot2c_f32_bf16 v24, v240, v7
    v_dot2c_f32_bf16 v25, v240, v8
    v_dot2c_f32_bf16 v26, v241, v7
    v_dot2c_f32_bf16 v27, v241, v8
    v_dot2c_f32_bf16 v28, v242, v7
    v_dot2c_f32_bf16 v29, v242, v8
    v_dot2c_f32_bf16 v30, v243, v7
    v_dot2c_f32_bf16 v31, v243, v8
    v_dot2c_f32_bf16 v32, v244, v7
    v_dot2c_f32_bf16 v33, v244, v8
    v_dot2c_f32_bf16 v34, v245, v7
    v_dot2c_f32_bf16 v35, v245, v8
    v_dot2c_f32_bf16 v36, v246, v7
    v_dot2c_f32_bf16 v37, v246, v8
    v_dot2c_f32_bf16 v38, v247, v7
    v_dot2c_f32_bf16 v39, v247, v8
    buffer_load_dwordx4 v[44:47], v103, s[24:27], s65 offen sc1
    s_add_u32 s48, s99, 3
    s_and_b32 s48, s48, 3
    s_mul_i32 s48, s48, 196608
    s_add_u32 s48, s48, s49
    buffer_load_dwordx4 v[124:127], v4, s[8:11], s48 offen offset:0 nt
    buffer_load_dwordx4 v[128:131], v4, s[8:11], s48 offen offset:128 nt
    buffer_load_dwordx4 v[132:135], v4, s[8:11], s48 offen offset:256 nt
    s_add_u32 s48, s48, 3072
    s_waitcnt vmcnt(2)
    v_cvt_pk_bf16_f32 v7, v75, 0
    v_cvt_pk_bf16_f32 v8, 0, v75
    v_dot2c_f32_bf16 v16, v112, v7
    v_dot2c_f32_bf16 v17, v112, v8
    v_dot2c_f32_bf16 v18, v113, v7
    v_dot2c_f32_bf16 v19, v113, v8
    v_dot2c_f32_bf16 v20, v114, v7
    v_dot2c_f32_bf16 v21, v114, v8
    v_dot2c_f32_bf16 v22, v115, v7
    v_dot2c_f32_bf16 v23, v115, v8
    v_dot2c_f32_bf16 v24, v116, v7
    v_dot2c_f32_bf16 v25, v116, v8
    v_dot2c_f32_bf16 v26, v117, v7
    v_dot2c_f32_bf16 v27, v117, v8
    v_dot2c_f32_bf16 v28, v118, v7
    v_dot2c_f32_bf16 v29, v118, v8
    v_dot2c_f32_bf16 v30, v119, v7
    v_dot2c_f32_bf16 v31, v119, v8
    v_dot2c_f32_bf16 v32, v120, v7
    v_dot2c_f32_bf16 v33, v120, v8
    v_dot2c_f32_bf16 v34, v121, v7
    v_dot2c_f32_bf16 v35, v121, v8
    v_dot2c_f32_bf16 v36, v122, v7
    v_dot2c_f32_bf16 v37, v122, v8
    v_dot2c_f32_bf16 v38, v123, v7
    v_dot2c_f32_bf16 v39, v123, v8
    buffer_load_dwordx4 v[136:139], v4, s[8:11], s48 offen offset:0 nt
    buffer_load_dwordx4 v[140:143], v4, s[8:11], s48 offen offset:128 nt
    buffer_load_dwordx4 v[144:147], v4, s[8:11], s48 offen offset:256 nt
    s_add_u32 s48, s48, 3072
    v_mov_b32 v252, 1
    v_mov_b32 v253, 0
    s_mov_b64 exec, 1
    buffer_atomic_add_x2 v[252:253], v88, s[24:27], s50 offen sc0
    s_mov_b64 exec, -1
    s_waitcnt vmcnt(2)
    v_cvt_pk_bf16_f32 v7, v76, 0
    v_cvt_pk_bf16_f32 v8, 0, v76
    v_dot2c_f32_bf16 v16, v124, v7
    v_dot2c_f32_bf16 v17, v124, v8
    v_dot2c_f32_bf16 v18, v125, v7
    v_dot2c_f32_bf16 v19, v125, v8
    v_dot2c_f32_bf16 v20, v126, v7
    v_dot2c_f32_bf16 v21, v126, v8
    v_dot2c_f32_bf16 v22, v127, v7
    v_dot2c_f32_bf16 v23, v127, v8
    v_dot2c_f32_bf16 v24, v128, v7
    v_dot2c_f32_bf16 v25, v128, v8
    v_dot2c_f32_bf16 v26, v129, v7
    v_dot2c_f32_bf16 v27, v129, v8
    v_dot2c_f32_bf16 v28, v130, v7
    v_dot2c_f32_bf16 v29, v130, v8
    v_dot2c_f32_bf16 v30, v131, v7
    v_dot2c_f32_bf16 v31, v131, v8
    v_dot2c_f32_bf16 v32, v132, v7
    v_dot2c_f32_bf16 v33, v132, v8
    v_dot2c_f32_bf16 v34, v133, v7
    v_dot2c_f32_bf16 v35, v133, v8
    v_dot2c_f32_bf16 v36, v134, v7
    v_dot2c_f32_bf16 v37, v134, v8
    v_dot2c_f32_bf16 v38, v135, v7
    v_dot2c_f32_bf16 v39, v135, v8
    s_add_u32 s58, s40, 0
    s_lshr_b32 s48, s58, 4
    s_add_u32 s48, s48, 26
    s_and_b32 s51, s48, 7
    s_mul_i32 s51, s51, 3072
    s_lshr_b32 s48, s48, 3
    s_bfe_u32 s55, s58, 0x10003
    s_add_u32 s48, s48, s55
    s_add_u32 s48, s48, s98
    s_and_b32 s48, s48, 3
    s_lshl_b32 s55, s55, 2
    s_add_u32 s48, s48, s55
    s_mul_i32 s48, s48, 196608
    s_add_u32 s51, s51, s48
    s_and_b32 s48, s58, 7
    s_mul_i32 s48, s48, 24576
    s_add_u32 s51, s51, s48
    s_add_u32 s51, s51, s42
    s_lshl_b32 s48, s58, 6
    s_add_u32 s48, s48, s41
    s_mov_b32 s94, s48
    buffer_load_dwordx2 v[248:249], v89, s[24:27], s48 offen sc1
    buffer_load_dwordx4 v[224:227], v4, s[8:11], s51 offen offset:0 nt
    buffer_load_dwordx4 v[228:231], v4, s[8:11], s51 offen offset:128 nt
    buffer_load_dwordx4 v[232:235], v4, s[8:11], s51 offen offset:256 nt
    v_mov_b32 v254, 1
    v_mov_b32 v255, 0
    s_mov_b64 exec, 1
    buffer_atomic_add_x2 v[254:255], v88, s[24:27], s50 offen sc0
    s_mov_b64 exec, -1
    s_waitcnt vmcnt(4)
    v_cvt_pk_bf16_f32 v7, v77, 0
    v_cvt_pk_bf16_f32 v8, 0, v77
    v_dot2c_f32_bf16 v16, v136, v7
    v_dot2c_f32_bf16 v17, v136, v8
    v_dot2c_f32_bf16 v18, v137, v7
    v_dot2c_f32_bf16 v19, v137, v8
    v_dot2c_f32_bf16 v20, v138, v7
    v_dot2c_f32_bf16 v21, v138, v8
    v_dot2c_f32_bf16 v22, v139, v7
    v_dot2c_f32_bf16 v23, v139, v8
    v_dot2c_f32_bf16 v24, v140, v7
    v_dot2c_f32_bf16 v25, v140, v8
    v_dot2c_f32_bf16 v26, v141, v7
    v_dot2c_f32_bf16 v27, v141, v8
    v_dot2c_f32_bf16 v28, v142, v7
    v_dot2c_f32_bf16 v29, v142, v8
    v_dot2c_f32_bf16 v30, v143, v7
    v_dot2c_f32_bf16 v31, v143, v8
    v_dot2c_f32_bf16 v32, v144, v7
    v_dot2c_f32_bf16 v33, v144, v8
    v_dot2c_f32_bf16 v34, v145, v7
    v_dot2c_f32_bf16 v35, v145, v8
    v_dot2c_f32_bf16 v36, v146, v7
    v_dot2c_f32_bf16 v37, v146, v8
    v_dot2c_f32_bf16 v38, v147, v7
    v_dot2c_f32_bf16 v39, v147, v8
    s_add_u32 s58, s40, 16
    s_lshr_b32 s48, s58, 4
    s_add_u32 s48, s48, 26
    s_and_b32 s51, s48, 7
    s_mul_i32 s51, s51, 3072
    s_lshr_b32 s48, s48, 3
    s_bfe_u32 s55, s58, 0x10003
    s_add_u32 s48, s48, s55
    s_add_u32 s48, s48, s98
    s_and_b32 s48, s48, 3
    s_lshl_b32 s55, s55, 2
    s_add_u32 s48, s48, s55
    s_mul_i32 s48, s48, 196608
    s_add_u32 s51, s51, s48
    s_and_b32 s48, s58, 7
    s_mul_i32 s48, s48, 24576
    s_add_u32 s51, s51, s48
    s_add_u32 s51, s51, s42
    s_lshl_b32 s48, s58, 6
    s_add_u32 s48, s48, s41
    s_mov_b32 s95, s48
    buffer_load_dwordx2 v[250:251], v89, s[24:27], s48 offen sc1
    buffer_load_dwordx4 v[236:239], v4, s[8:11], s51 offen offset:0 nt
    buffer_load_dwordx4 v[240:243], v4, s[8:11], s51 offen offset:128 nt
    buffer_load_dwordx4 v[244:247], v4, s[8:11], s51 offen offset:256 nt
    v_mov_b32 v110, 1
    v_mov_b32 v111, 0
    s_mov_b64 exec, 1
    buffer_atomic_add_x2 v[110:111], v88, s[24:27], s50 offen sc0
    s_mov_b64 exec, -1
    v_xor_b32 v45, s52, v45
    v_xor_b32 v47, s52, v47
    v_or_b32 v7, v45, v47
    v_cmp_ne_u32 vcc, 0, v7
    s_nop 4
    s_cbranch_vccz L_stspin_done
    s_mov_b32 s43, 60000
L_stspin_re:
    s_nop 4
    s_mov_b32 s60, 32
L_stspin:
    s_nop 4
    buffer_load_dwordx4 v[44:47], v103, s[24:27], s65 offen sc1
    s_waitcnt vmcnt(0)
    v_xor_b32 v45, s52, v45
    v_xor_b32 v47, s52, v47
    v_or_b32 v7, v45, v47
    v_cmp_ne_u32 vcc, 0, v7
    s_nop 4
    s_cbranch_vccz L_stspin_done
    s_sleep 1
    s_sub_u32 s60, s60, 1
    s_cmp_lg_u32 s60, 0
    s_cbranch_scc1 L_stspin
    s_branch L_stspin_slow
L_stspin_done:
    s_nop 4
    v_mov_b32 v220, v44
    s_nop 1
    v_max_f32_dpp v220, v220, v220 quad_perm:[1,0,3,2] row_mask:0xf bank_mask:0xf
    s_nop 1
    v_max_f32_dpp v220, v220, v220 quad_perm:[2,3,0,1] row_mask:0xf bank_mask:0xf
    s_nop 1
    v_max_f32_dpp v220, v220, v220 row_half_mirror row_mask:0xf bank_mask:0xf
    s_nop 1
    v_max_f32_dpp v220, v220, v220 row_mirror row_mask:0xf bank_mask:0xf
    v_sub_f32 v40, v44, v220
    v_mul_f32 v40, s53, v40
    v_exp_f32 v40, v40
    s_nop 0
    v_mul_f32 v40, v40, v46
    s_nop 1
    v_add_f32_dpp v40, v40, v40 quad_perm:[1,0,3,2] row_mask:0xf bank_mask:0xf
    s_nop 1
    v_add_f32_dpp v40, v40, v40 quad_perm:[2,3,0,1] row_mask:0xf bank_mask:0xf
    s_nop 1
    v_add_f32_dpp v40, v40, v40 row_half_mirror row_mask:0xf bank_mask:0xf
    s_nop 1
    v_add_f32_dpp v40, v40, v40 row_mirror row_mask:0xf bank_mask:0xf
    v_rcp_f32 v221, v40
    s_cmp_lt_u32 s46, 3
    s_cbranch_scc1 L_notr
    v_mov_b32 v7, 9728
L_cntspin:
    s_nop 4
    ds_read_b32 v8, v7
    s_waitcnt lgkmcnt(0)
    v_readfirstlane_b32 s58, v8
    s_nop 1
    s_cmp_ge_u32 s58, 8
    s_cbranch_scc1 L_cntspin_ok
    s_sleep 1
    s_branch L_cntspin
L_cntspin_ok:
    s_nop 4
    v_lshrrev_b32 v7, 4, v1
    v_bfe_u32 v8, v1, 2, 2
    v_lshl_add_u32 v7, v7, 3, v8
    v_lshlrev_b32 v7, 8, v7
    v_and_b32 v8, 3, v1
    v_lshl_add_u32 v7, v8, 3, v7
    s_lshl_b32 s58, s3, 5
    s_add_u32 s58, s58, 69632
    v_add_u32 v7, s58, v7
    ds_read_b64_tr_b16 v[112:113], v7 offset:0
    ds_read_b64_tr_b16 v[114:115], v7 offset:1024
    ds_read_b64_tr_b16 v[116:117], v7 offset:8192
    ds_read_b64_tr_b16 v[118:119], v7 offset:9216
    ds_read_b64_tr_b16 v[120:121], v7 offset:16384
    ds_read_b64_tr_b16 v[122:123], v7 offset:17408
    ds_read_b64_tr_b16 v[124:125], v7 offset:24576
    ds_read_b64_tr_b16 v[126:127], v7 offset:25600
    ds_read_b64_tr_b16 v[128:129], v7 offset:32768
    ds_read_b64_tr_b16 v[130:131], v7 offset:33792
    ds_read_b64_tr_b16 v[132:133], v7 offset:40960
    ds_read_b64_tr_b16 v[134:135], v7 offset:41984
    s_waitcnt lgkmcnt(0)
L_notr:
    s_nop 4
    s_mov_b32 s96, 1
    s_mov_b32 s97, 1
    s_mov_b32 s49, 1
    s_mov_b32 s100, 1
    s_mov_b32 s101, 1
    s_mov_b32 s91, 1
    v_mov_b32 v91, 0
L_dyn:
    s_nop 4
    s_waitcnt vmcnt(6)
    s_cmp_eq_u32 s96, 0
    s_cbranch_scc1 L_dynend
    v_cmp_ne_u32 vcc, s52, v249
    v_readfirstlane_b32 s58, v252
    v_readfirstlane_b32 s59, v253
    s_nop 2
    s_cbranch_vccnz L_sbad0
L_sok0:
    s_nop 4
    v_max_f32 v86, v84, v248
    v_sub_f32 v87, v84, v86
    v_sub_f32 v92, v248, v86
    v_mul_f32 v87, s53, v87
    v_mul_f32 v92, s53, v92
    v_exp_f32 v87, v87
    v_exp_f32 v92, v92
    v_mov_b32 v84, v86
    s_cmp_lg_u32 s59, s52
    s_cbranch_scc1 L_cbad0
L_cok0:
    s_nop 4
    v_cvt_pk_bf16_f32 v7, v92, 0
    v_cvt_pk_bf16_f32 v8, 0, v92
    s_cmp_lt_u32 s58, 96
    s_cselect_b32 s96, s100, 0
    s_cmp_lt_u32 s58, s64
    s_cselect_b32 s49, s49, 0
    s_mov_b32 s100, s49
    s_lshr_b32 s48, s58, 4
    s_add_u32 s48, s48, 26
    s_and_b32 s51, s48, 7
    s_mul_i32 s51, s51, 3072
    s_lshr_b32 s48, s48, 3
    s_bfe_u32 s55, s58, 0x10003
    s_add_u32 s48, s48, s55
    s_add_u32 s48, s48, s98
    s_and_b32 s48, s48, 3
    s_lshl_b32 s55, s55, 2
    s_add_u32 s48, s48, s55
    s_mul_i32 s48, s48, 196608
    s_add_u32 s51, s51, s48
    s_and_b32 s48, s58, 7
    s_mul_i32 s48, s48, 24576
    s_add_u32 s51, s51, s48
    s_add_u32 s51, s51, s42
    s_lshl_b32 s48, s58, 6
    s_add_u32 s48, s48, s41
    s_cmp_lg_u32 s96, 0
    s_cselect_b32 s51, s51, 0xf0000000
    s_cselect_b32 s48, s48, 0xf0000000
    s_mov_b32 s94, s48
    v_mul_f32 v16, v16, v87
    v_mul_f32 v17, v17, v87
    v_mul_f32 v18, v18, v87
    v_mul_f32 v19, v19, v87
    v_mul_f32 v20, v20, v87
    v_mul_f32 v21, v21, v87
    v_mul_f32 v22, v22, v87
    v_mul_f32 v23, v23, v87
    v_mul_f32 v24, v24, v87
    v_mul_f32 v25, v25, v87
    v_mul_f32 v26, v26, v87
    v_mul_f32 v27, v27, v87
    v_mul_f32 v28, v28, v87
    v_mul_f32 v29, v29, v87
    v_mul_f32 v30, v30, v87
    v_mul_f32 v31, v31, v87
    v_mul_f32 v32, v32, v87
    v_mul_f32 v33, v33, v87
    v_mul_f32 v34, v34, v87
    v_mul_f32 v35, v35, v87
    v_mul_f32 v36, v36, v87
    v_mul_f32 v37, v37, v87
    v_mul_f32 v38, v38, v87
    v_mul_f32 v39, v39, v87
    v_dot2c_f32_bf16 v16, v224, v7
    v_dot2c_f32_bf16 v17, v224, v8
    v_dot2c_f32_bf16 v18, v225, v7
    v_dot2c_f32_bf16 v19, v225, v8
    v_dot2c_f32_bf16 v20, v226, v7
    v_dot2c_f32_bf16 v21, v226, v8
    v_dot2c_f32_bf16 v22, v227, v7
    v_dot2c_f32_bf16 v23, v227, v8
    v_dot2c_f32_bf16 v24, v228, v7
    v_dot2c_f32_bf16 v25, v228, v8
    v_dot2c_f32_bf16 v26, v229, v7
    v_dot2c_f32_bf16 v27, v229, v8
    v_dot2c_f32_bf16 v28, v230, v7
    v_dot2c_f32_bf16 v29, v230, v8
    v_dot2c_f32_bf16 v30, v231, v7
    v_dot2c_f32_bf16 v31, v231, v8
    v_dot2c_f32_bf16 v32, v232, v7
    v_dot2c_f32_bf16 v33, v232, v8
    v_dot2c_f32_bf16 v34, v233, v7
    v_dot2c_f32_bf16 v35, v233, v8
    v_dot2c_f32_bf16 v36, v234, v7
    v_dot2c_f32_bf16 v37, v234, v8
    v_dot2c_f32_bf16 v38, v235, v7
    v_dot2c_f32_bf16 v39, v235, v8
    buffer_load_dwordx2 v[248:249], v89, s[24:27], s48 offen sc1
    buffer_load_dwordx4 v[224:227], v4, s[8:11], s51 offen offset:0 nt
    buffer_load_dwordx4 v[228:231], v4, s[8:11], s51 offen offset:128 nt
    buffer_load_dwordx4 v[232:235], v4, s[8:11], s51 offen offset:256 nt
    v_mov_b32 v252, s49
    v_mov_b32 v253, 0
    s_mov_b64 exec, 1
    buffer_atomic_add_x2 v[252:253], v88, s[24:27], s50 offen sc0
    s_mov_b64 exec, -1
    s_waitcnt vmcnt(6)
    s_cmp_eq_u32 s97, 0
    s_cbranch_scc1 L_dynend
    v_cmp_ne_u32 vcc, s52, v251
    v_readfirstlane_b32 s58, v254
    v_readfirstlane_b32 s59, v255
    s_nop 2
    s_cbranch_vccnz L_sbad1
L_sok1:
    s_nop 4
    v_max_f32 v86, v84, v250
    v_sub_f32 v87, v84, v86
    v_sub_f32 v92, v250, v86
    v_mul_f32 v87, s53, v87
    v_mul_f32 v92, s53, v92
    v_exp_f32 v87, v87
    v_exp_f32 v92, v92
    v_mov_b32 v84, v86
    s_cmp_lg_u32 s59, s52
    s_cbranch_scc1 L_cbad1
L_cok1:
    s_nop 4
    v_cvt_pk_bf16_f32 v7, v92, 0
    v_cvt_pk_bf16_f32 v8, 0, v92
    s_cmp_lt_u32 s58, 96
    s_cselect_b32 s97, s101, 0
    s_cmp_lt_u32 s58, s64
    s_cselect_b32 s49, s49, 0
    s_mov_b32 s101, s49
    s_lshr_b32 s48, s58, 4
    s_add_u32 s48, s48, 26
    s_and_b32 s51, s48, 7
    s_mul_i32 s51, s51, 3072
    s_lshr_b32 s48, s48, 3
    s_bfe_u32 s55, s58, 0x10003
    s_add_u32 s48, s48, s55
    s_add_u32 s48, s48, s98
    s_and_b32 s48, s48, 3
    s_lshl_b32 s55, s55, 2
    s_add_u32 s48, s48, s55
    s_mul_i32 s48, s48, 196608
    s_add_u32 s51, s51, s48
    s_and_b32 s48, s58, 7
    s_mul_i32 s48, s48, 24576
    s_add_u32 s51, s51, s48
    s_add_u32 s51, s51, s42
    s_lshl_b32 s48, s58, 6
    s_add_u32 s48, s48, s41
    s_cmp_lg_u32 s97, 0
    s_cselect_b32 s51, s51, 0xf0000000
    s_cselect_b32 s48, s48, 0xf0000000
    s_mov_b32 s95, s48
    v_mul_f32 v16, v16, v87
    v_mul_f32 v17, v17, v87
    v_mul_f32 v18, v18, v87
    v_mul_f32 v19, v19, v87
    v_mul_f32 v20, v20, v87
    v_mul_f32 v21, v21, v87
    v_mul_f32 v22, v22, v87
    v_mul_f32 v23, v23, v87
    v_mul_f32 v24, v24, v87
    v_mul_f32 v25, v25, v87
    v_mul_f32 v26, v26, v87
    v_mul_f32 v27, v27, v87
    v_mul_f32 v28, v28, v87
    v_mul_f32 v29, v29, v87
    v_mul_f32 v30, v30, v87
    v_mul_f32 v31, v31, v87
    v_mul_f32 v32, v32, v87
    v_mul_f32 v33, v33, v87
    v_mul_f32 v34, v34, v87
    v_mul_f32 v35, v35, v87
    v_mul_f32 v36, v36, v87
    v_mul_f32 v37, v37, v87
    v_mul_f32 v38, v38, v87
    v_mul_f32 v39, v39, v87
    v_dot2c_f32_bf16 v16, v236, v7
    v_dot2c_f32_bf16 v17, v236, v8
    v_dot2c_f32_bf16 v18, v237, v7
    v_dot2c_f32_bf16 v19, v237, v8
    v_dot2c_f32_bf16 v20, v238, v7
    v_dot2c_f32_bf16 v21, v238, v8
    v_dot2c_f32_bf16 v22, v239, v7
    v_dot2c_f32_bf16 v23, v239, v8
    v_dot2c_f32_bf16 v24, v240, v7
    v_dot2c_f32_bf16 v25, v240, v8
    v_dot2c_f32_bf16 v26, v241, v7
    v_dot2c_f32_bf16 v27, v241, v8
    v_dot2c_f32_bf16 v28, v242, v7
    v_dot2c_f32_bf16 v29, v242, v8
    v_dot2c_f32_bf16 v30, v243, v7
    v_dot2c_f32_bf16 v31, v243, v8
    v_dot2c_f32_bf16 v32, v244, v7
    v_dot2c_f32_bf16 v33, v244, v8
    v_dot2c_f32_bf16 v34, v245, v7
    v_dot2c_f32_bf16 v35, v245, v8
    v_dot2c_f32_bf16 v36, v246, v7
    v_dot2c_f32_bf16 v37, v246, v8
    v_dot2c_f32_bf16 v38, v247, v7
    v_dot2c_f32_bf16 v39, v247, v8
    buffer_load_dwordx2 v[250:251], v89, s[24:27], s48 offen sc1
    buffer_load_dwordx4 v[236:239], v4, s[8:11], s51 offen offset:0 nt
    buffer_load_dwordx4 v[240:243], v4, s[8:11], s51 offen offset:128 nt
    buffer_load_dwordx4 v[244:247], v4, s[8:11], s51 offen offset:256 nt
    v_mov_b32 v254, s49
    v_mov_b32 v255, 0
    s_mov_b64 exec, 1
    buffer_atomic_add_x2 v[254:255], v88, s[24:27], s50 offen sc0
    s_mov_b64 exec, -1
    s_waitcnt vmcnt(6)
    s_cmp_eq_u32 s96, 0
    s_cbranch_scc1 L_dynend
    v_cmp_ne_u32 vcc, s52, v249
    v_readfirstlane_b32 s58, v110
    v_readfirstlane_b32 s59, v111
    s_nop 2
    s_cbranch_vccnz L_sbad2
L_sok2:
    s_nop 4
    v_max_f32 v86, v84, v248
    v_sub_f32 v87, v84, v86
    v_sub_f32 v92, v248, v86
    v_mul_f32 v87, s53, v87
    v_mul_f32 v92, s53, v92
    v_exp_f32 v87, v87
    v_exp_f32 v92, v92
    v_mov_b32 v84, v86
    s_cmp_lg_u32 s59, s52
    s_cbranch_scc1 L_cbad2
L_cok2:
    s_nop 4
    v_cvt_pk_bf16_f32 v7, v92, 0
    v_cvt_pk_bf16_f32 v8, 0, v92
    s_cmp_lt_u32 s58, 96
    s_cselect_b32 s96, s91, 0
    s_cmp_lt_u32 s58, s64
    s_cselect_b32 s49, s49, 0
    s_mov_b32 s91, s49
    s_lshr_b32 s48, s58, 4
    s_add_u32 s48, s48, 26
    s_and_b32 s51, s48, 7
    s_mul_i32 s51, s51, 3072
    s_lshr_b32 s48, s48, 3
    s_bfe_u32 s55, s58, 0x10003
    s_add_u32 s48, s48, s55
    s_add_u32 s48, s48, s98
    s_and_b32 s48, s48, 3
    s_lshl_b32 s55, s55, 2
    s_add_u32 s48, s48, s55
    s_mul_i32 s48, s48, 196608
    s_add_u32 s51, s51, s48
    s_and_b32 s48, s58, 7
    s_mul_i32 s48, s48, 24576
    s_add_u32 s51, s51, s48
    s_add_u32 s51, s51, s42
    s_lshl_b32 s48, s58, 6
    s_add_u32 s48, s48, s41
    s_cmp_lg_u32 s96, 0
    s_cselect_b32 s51, s51, 0xf0000000
    s_cselect_b32 s48, s48, 0xf0000000
    s_mov_b32 s94, s48
    v_mul_f32 v16, v16, v87
    v_mul_f32 v17, v17, v87
    v_mul_f32 v18, v18, v87
    v_mul_f32 v19, v19, v87
    v_mul_f32 v20, v20, v87
    v_mul_f32 v21, v21, v87
    v_mul_f32 v22, v22, v87
    v_mul_f32 v23, v23, v87
    v_mul_f32 v24, v24, v87
    v_mul_f32 v25, v25, v87
    v_mul_f32 v26, v26, v87
    v_mul_f32 v27, v27, v87
    v_mul_f32 v28, v28, v87
    v_mul_f32 v29, v29, v87
    v_mul_f32 v30, v30, v87
    v_mul_f32 v31, v31, v87
    v_mul_f32 v32, v32, v87
    v_mul_f32 v33, v33, v87
    v_mul_f32 v34, v34, v87
    v_mul_f32 v35, v35, v87
    v_mul_f32 v36, v36, v87
    v_mul_f32 v37, v37, v87
    v_mul_f32 v38, v38, v87
    v_mul_f32 v39, v39, v87
    v_dot2c_f32_bf16 v16, v224, v7
    v_dot2c_f32_bf16 v17, v224, v8
    v_dot2c_f32_bf16 v18, v225, v7
    v_dot2c_f32_bf16 v19, v225, v8
    v_dot2c_f32_bf16 v20, v226, v7
    v_dot2c_f32_bf16 v21, v226, v8
    v_dot2c_f32_bf16 v22, v227, v7
    v_dot2c_f32_bf16 v23, v227, v8
    v_dot2c_f32_bf16 v24, v228, v7
    v_dot2c_f32_bf16 v25, v228, v8
    v_dot2c_f32_bf16 v26, v229, v7
    v_dot2c_f32_bf16 v27, v229, v8
    v_dot2c_f32_bf16 v28, v230, v7
    v_dot2c_f32_bf16 v29, v230, v8
    v_dot2c_f32_bf16 v30, v231, v7
    v_dot2c_f32_bf16 v31, v231, v8
    v_dot2c_f32_bf16 v32, v232, v7
    v_dot2c_f32_bf16 v33, v232, v8
    v_dot2c_f32_bf16 v34, v233, v7
    v_dot2c_f32_bf16 v35, v233, v8
    v_dot2c_f32_bf16 v36, v234, v7
    v_dot2c_f32_bf16 v37, v234, v8
    v_dot2c_f32_bf16 v38, v235, v7
    v_dot2c_f32_bf16 v39, v235, v8
    buffer_load_dwordx2 v[248:249], v89, s[24:27], s48 offen sc1
    buffer_load_dwordx4 v[224:227], v4, s[8:11], s51 offen offset:0 nt
    buffer_load_dwordx4 v[228:231], v4, s[8:11], s51 offen offset:128 nt
    buffer_load_dwordx4 v[232:235], v4, s[8:11], s51 offen offset:256 nt
    v_mov_b32 v110, s49
    v_mov_b32 v111, 0
    s_mov_b64 exec, 1
    buffer_atomic_add_x2 v[110:111], v88, s[24:27], s50 offen sc0
    s_mov_b64 exec, -1
    s_waitcnt vmcnt(6)
    s_cmp_eq_u32 s97, 0
    s_cbranch_scc1 L_dynend
    v_cmp_ne_u32 vcc, s52, v251
    v_readfirstlane_b32 s58, v252
    v_readfirstlane_b32 s59, v253
    s_nop 2
    s_cbranch_vccnz L_sbad3
L_sok3:
    s_nop 4
    v_max_f32 v86, v84, v250
    v_sub_f32 v87, v84, v86
    v_sub_f32 v92, v250, v86
    v_mul_f32 v87, s53, v87
    v_mul_f32 v92, s53, v92
    v_exp_f32 v87, v87
    v_exp_f32 v92, v92
    v_mov_b32 v84, v86
    s_cmp_lg_u32 s59, s52
    s_cbranch_scc1 L_cbad3
L_cok3:
    s_nop 4
    v_cvt_pk_bf16_f32 v7, v92, 0
    v_cvt_pk_bf16_f32 v8, 0, v92
    s_cmp_lt_u32 s58, 96
    s_cselect_b32 s97, s100, 0
    s_cmp_lt_u32 s58, s64
    s_cselect_b32 s49, s49, 0
    s_mov_b32 s100, s49
    s_lshr_b32 s48, s58, 4
    s_add_u32 s48, s48, 26
    s_and_b32 s51, s48, 7
    s_mul_i32 s51, s51, 3072
    s_lshr_b32 s48, s48, 3
    s_bfe_u32 s55, s58, 0x10003
    s_add_u32 s48, s48, s55
    s_add_u32 s48, s48, s98
    s_and_b32 s48, s48, 3
    s_lshl_b32 s55, s55, 2
    s_add_u32 s48, s48, s55
    s_mul_i32 s48, s48, 196608
    s_add_u32 s51, s51, s48
    s_and_b32 s48, s58, 7
    s_mul_i32 s48, s48, 24576
    s_add_u32 s51, s51, s48
    s_add_u32 s51, s51, s42
    s_lshl_b32 s48, s58, 6
    s_add_u32 s48, s48, s41
    s_cmp_lg_u32 s97, 0
    s_cselect_b32 s51, s51, 0xf0000000
    s_cselect_b32 s48, s48, 0xf0000000
    s_mov_b32 s95, s48
    v_mul_f32 v16, v16, v87
    v_mul_f32 v17, v17, v87
    v_mul_f32 v18, v18, v87
    v_mul_f32 v19, v19, v87
    v_mul_f32 v20, v20, v87
    v_mul_f32 v21, v21, v87
    v_mul_f32 v22, v22, v87
    v_mul_f32 v23, v23, v87
    v_mul_f32 v24, v24, v87
    v_mul_f32 v25, v25, v87
    v_mul_f32 v26, v26, v87
    v_mul_f32 v27, v27, v87
    v_mul_f32 v28, v28, v87
    v_mul_f32 v29, v29, v87
    v_mul_f32 v30, v30, v87
    v_mul_f32 v31, v31, v87
    v_mul_f32 v32, v32, v87
    v_mul_f32 v33, v33, v87
    v_mul_f32 v34, v34, v87
    v_mul_f32 v35, v35, v87
    v_mul_f32 v36, v36, v87
    v_mul_f32 v37, v37, v87
    v_mul_f32 v38, v38, v87
    v_mul_f32 v39, v39, v87
    v_dot2c_f32_bf16 v16, v236, v7
    v_dot2c_f32_bf16 v17, v236, v8
    v_dot2c_f32_bf16 v18, v237, v7
    v_dot2c_f32_bf16 v19, v237, v8
    v_dot2c_f32_bf16 v20, v238, v7
    v_dot2c_f32_bf16 v21, v238, v8
    v_dot2c_f32_bf16 v22, v239, v7
    v_dot2c_f32_bf16 v23, v239, v8
    v_dot2c_f32_bf16 v24, v240, v7
    v_dot2c_f32_bf16 v25, v240, v8
    v_dot2c_f32_bf16 v26, v241, v7
    v_dot2c_f32_bf16 v27, v241, v8
    v_dot2c_f32_bf16 v28, v242, v7
    v_dot2c_f32_bf16 v29, v242, v8
    v_dot2c_f32_bf16 v30, v243, v7
    v_dot2c_f32_bf16 v31, v243, v8
    v_dot2c_f32_bf16 v32, v244, v7
    v_dot2c_f32_bf16 v33, v244, v8
    v_dot2c_f32_bf16 v34, v245, v7
    v_dot2c_f32_bf16 v35, v245, v8
    v_dot2c_f32_bf16 v36, v246, v7
    v_dot2c_f32_bf16 v37, v246, v8
    v_dot2c_f32_bf16 v38, v247, v7
    v_dot2c_f32_bf16 v39, v247, v8
    buffer_load_dwordx2 v[250:251], v89, s[24:27], s48 offen sc1
    buffer_load_dwordx4 v[236:239], v4, s[8:11], s51 offen offset:0 nt
    buffer_load_dwordx4 v[240:243], v4, s[8:11], s51 offen offset:128 nt
    buffer_load_dwordx4 v[244:247], v4, s[8:11], s51 offen offset:256 nt
    v_mov_b32 v252, s49
    v_mov_b32 v253, 0
    s_mov_b64 exec, 1
    buffer_atomic_add_x2 v[252:253], v88, s[24:27], s50 offen sc0
    s_mov_b64 exec, -1
    s_waitcnt vmcnt(6)
    s_cmp_eq_u32 s96, 0
    s_cbranch_scc1 L_dynend
    v_cmp_ne_u32 vcc, s52, v249
    v_readfirstlane_b32 s58, v254
    v_readfirstlane_b32 s59, v255
    s_nop 2
    s_cbranch_vccnz L_sbad4
L_sok4:
    s_nop 4
    v_max_f32 v86, v84, v248
    v_sub_f32 v87, v84, v86
    v_sub_f32 v92, v248, v86
    v_mul_f32 v87, s53, v87
    v_mul_f32 v92, s53, v92
    v_exp_f32 v87, v87
    v_exp_f32 v92, v92
    v_mov_b32 v84, v86
    s_cmp_lg_u32 s59, s52
    s_cbranch_scc1 L_cbad4
L_cok4:
    s_nop 4
    v_cvt_pk_bf16_f32 v7, v92, 0
    v_cvt_pk_bf16_f32 v8, 0, v92
    s_cmp_lt_u32 s58, 96
    s_cselect_b32 s96, s101, 0
    s_cmp_lt_u32 s58, s64
    s_cselect_b32 s49, s49, 0
    s_mov_b32 s101, s49
    s_lshr_b32 s48, s58, 4
    s_add_u32 s48, s48, 26
    s_and_b32 s51, s48, 7
    s_mul_i32 s51, s51, 3072
    s_lshr_b32 s48, s48, 3
    s_bfe_u32 s55, s58, 0x10003
    s_add_u32 s48, s48, s55
    s_add_u32 s48, s48, s98
    s_and_b32 s48, s48, 3
    s_lshl_b32 s55, s55, 2
    s_add_u32 s48, s48, s55
    s_mul_i32 s48, s48, 196608
    s_add_u32 s51, s51, s48
    s_and_b32 s48, s58, 7
    s_mul_i32 s48, s48, 24576
    s_add_u32 s51, s51, s48
    s_add_u32 s51, s51, s42
    s_lshl_b32 s48, s58, 6
    s_add_u32 s48, s48, s41
    s_cmp_lg_u32 s96, 0
    s_cselect_b32 s51, s51, 0xf0000000
    s_cselect_b32 s48, s48, 0xf0000000
    s_mov_b32 s94, s48
    v_mul_f32 v16, v16, v87
    v_mul_f32 v17, v17, v87
    v_mul_f32 v18, v18, v87
    v_mul_f32 v19, v19, v87
    v_mul_f32 v20, v20, v87
    v_mul_f32 v21, v21, v87
    v_mul_f32 v22, v22, v87
    v_mul_f32 v23, v23, v87
    v_mul_f32 v24, v24, v87
    v_mul_f32 v25, v25, v87
    v_mul_f32 v26, v26, v87
    v_mul_f32 v27, v27, v87
    v_mul_f32 v28, v28, v87
    v_mul_f32 v29, v29, v87
    v_mul_f32 v30, v30, v87
    v_mul_f32 v31, v31, v87
    v_mul_f32 v32, v32, v87
    v_mul_f32 v33, v33, v87
    v_mul_f32 v34, v34, v87
    v_mul_f32 v35, v35, v87
    v_mul_f32 v36, v36, v87
    v_mul_f32 v37, v37, v87
    v_mul_f32 v38, v38, v87
    v_mul_f32 v39, v39, v87
    v_dot2c_f32_bf16 v16, v224, v7
    v_dot2c_f32_bf16 v17, v224, v8
    v_dot2c_f32_bf16 v18, v225, v7
    v_dot2c_f32_bf16 v19, v225, v8
    v_dot2c_f32_bf16 v20, v226, v7
    v_dot2c_f32_bf16 v21, v226, v8
    v_dot2c_f32_bf16 v22, v227, v7
    v_dot2c_f32_bf16 v23, v227, v8
    v_dot2c_f32_bf16 v24, v228, v7
    v_dot2c_f32_bf16 v25, v228, v8
    v_dot2c_f32_bf16 v26, v229, v7
    v_dot2c_f32_bf16 v27, v229, v8
    v_dot2c_f32_bf16 v28, v230, v7
    v_dot2c_f32_bf16 v29, v230, v8
    v_dot2c_f32_bf16 v30, v231, v7
    v_dot2c_f32_bf16 v31, v231, v8
    v_dot2c_f32_bf16 v32, v232, v7
    v_dot2c_f32_bf16 v33, v232, v8
    v_dot2c_f32_bf16 v34, v233, v7
    v_dot2c_f32_bf16 v35, v233, v8
    v_dot2c_f32_bf16 v36, v234, v7
    v_dot2c_f32_bf16 v37, v234, v8
    v_dot2c_f32_bf16 v38, v235, v7
    v_dot2c_f32_bf16 v39, v235, v8
    buffer_load_dwordx2 v[248:249], v89, s[24:27], s48 offen sc1
    buffer_load_dwordx4 v[224:227], v4, s[8:11], s51 offen offset:0 nt
    buffer_load_dwordx4 v[228:231], v4, s[8:11], s51 offen offset:128 nt
    buffer_load_dwordx4 v[232:235], v4, s[8:11], s51 offen offset:256 nt
    v_mov_b32 v254, s49
    v_mov_b32 v255, 0
    s_mov_b64 exec, 1
    buffer_atomic_add_x2 v[254:255], v88, s[24:27], s50 offen sc0
    s_mov_b64 exec, -1
    s_waitcnt vmcnt(6)
    s_cmp_eq_u32 s97, 0
    s_cbranch_scc1 L_dynend
    v_cmp_ne_u32 vcc, s52, v251
    v_readfirstlane_b32 s58, v110
    v_readfirstlane_b32 s59, v111
    s_nop 2
    s_cbranch_vccnz L_sbad5
L_sok5:
    s_nop 4
    v_max_f32 v86, v84, v250
    v_sub_f32 v87, v84, v86
    v_sub_f32 v92, v250, v86
    v_mul_f32 v87, s53, v87
    v_mul_f32 v92, s53, v92
    v_exp_f32 v87, v87
    v_exp_f32 v92, v92
    v_mov_b32 v84, v86
    s_cmp_lg_u32 s59, s52
    s_cbranch_scc1 L_cbad5
L_cok5:
    s_nop 4
    v_cvt_pk_bf16_f32 v7, v92, 0
    v_cvt_pk_bf16_f32 v8, 0, v92
    s_cmp_lt_u32 s58, 96
    s_cselect_b32 s97, s91, 0
    s_cmp_lt_u32 s58, s64
    s_cselect_b32 s49, s49, 0
    s_mov_b32 s91, s49
    s_lshr_b32 s48, s58, 4
    s_add_u32 s48, s48, 26
    s_and_b32 s51, s48, 7
    s_mul_i32 s51, s51, 3072
    s_lshr_b32 s48, s48, 3
    s_bfe_u32 s55, s58, 0x10003
    s_add_u32 s48, s48, s55
    s_add_u32 s48, s48, s98
    s_and_b32 s48, s48, 3
    s_lshl_b32 s55, s55, 2
    s_add_u32 s48, s48, s55
    s_mul_i32 s48, s48, 196608
    s_add_u32 s51, s51, s48
    s_and_b32 s48, s58, 7
    s_mul_i32 s48, s48, 24576
    s_add_u32 s51, s51, s48
    s_add_u32 s51, s51, s42
    s_lshl_b32 s48, s58, 6
    s_add_u32 s48, s48, s41
    s_cmp_lg_u32 s97, 0
    s_cselect_b32 s51, s51, 0xf0000000
    s_cselect_b32 s48, s48, 0xf0000000
    s_mov_b32 s95, s48
    v_mul_f32 v16, v16, v87
    v_mul_f32 v17, v17, v87
    v_mul_f32 v18, v18, v87
    v_mul_f32 v19, v19, v87
    v_mul_f32 v20, v20, v87
    v_mul_f32 v21, v21, v87
    v_mul_f32 v22, v22, v87
    v_mul_f32 v23, v23, v87
    v_mul_f32 v24, v24, v87
    v_mul_f32 v25, v25, v87
    v_mul_f32 v26, v26, v87
    v_mul_f32 v27, v27, v87
    v_mul_f32 v28, v28, v87
    v_mul_f32 v29, v29, v87
    v_mul_f32 v30, v30, v87
    v_mul_f32 v31, v31, v87
    v_mul_f32 v32, v32, v87
    v_mul_f32 v33, v33, v87
    v_mul_f32 v34, v34, v87
    v_mul_f32 v35, v35, v87
    v_mul_f32 v36, v36, v87
    v_mul_f32 v37, v37, v87
    v_mul_f32 v38, v38, v87
    v_mul_f32 v39, v39, v87
    v_dot2c_f32_bf16 v16, v236, v7
    v_dot2c_f32_bf16 v17, v236, v8
    v_dot2c_f32_bf16 v18, v237, v7
    v_dot2c_f32_bf16 v19, v237, v8
    v_dot2c_f32_bf16 v20, v238, v7
    v_dot2c_f32_bf16 v21, v238, v8
    v_dot2c_f32_bf16 v22, v239, v7
    v_dot2c_f32_bf16 v23, v239, v8
    v_dot2c_f32_bf16 v24, v240, v7
    v_dot2c_f32_bf16 v25, v240, v8
    v_dot2c_f32_bf16 v26, v241, v7
    v_dot2c_f32_bf16 v27, v241, v8
    v_dot2c_f32_bf16 v28, v242, v7
    v_dot2c_f32_bf16 v29, v242, v8
    v_dot2c_f32_bf16 v30, v243, v7
    v_dot2c_f32_bf16 v31, v243, v8
    v_dot2c_f32_bf16 v32, v244, v7
    v_dot2c_f32_bf16 v33, v244, v8
    v_dot2c_f32_bf16 v34, v245, v7
    v_dot2c_f32_bf16 v35, v245, v8
    v_dot2c_f32_bf16 v36, v246, v7
    v_dot2c_f32_bf16 v37, v246, v8
    v_dot2c_f32_bf16 v38, v247, v7
    v_dot2c_f32_bf16 v39, v247, v8
    buffer_load_dwordx2 v[250:251], v89, s[24:27], s48 offen sc1
    buffer_load_dwordx4 v[236:239], v4, s[8:11], s51 offen offset:0 nt
    buffer_load_dwordx4 v[240:243], v4, s[8:11], s51 offen offset:128 nt
    buffer_load_dwordx4 v[244:247], v4, s[8:11], s51 offen offset:256 nt
    v_mov_b32 v110, s49
    v_mov_b32 v111, 0
    s_mov_b64 exec, 1
    buffer_atomic_add_x2 v[110:111], v88, s[24:27], s50 offen sc0
    s_mov_b64 exec, -1
    s_branch L_dyn
L_dynend:
    s_nop 4
    s_mul_i32 s55, s2, 768
    s_add_u32 s55, s55, 196608
    v_sub_f32 v87, v84, v220
    v_mul_f32 v87, s53, v87
    v_exp_f32 v87, v87
    s_nop 0
    v_mul_f32 v87, v87, v221
    v_mul_f32 v16, v16, v87
    v_mul_f32 v17, v17, v87
    v_mul_f32 v18, v18, v87
    v_mul_f32 v19, v19, v87
    v_mul_f32 v20, v20, v87
    v_mul_f32 v21, v21, v87
    v_mul_f32 v22, v22, v87
    v_mul_f32 v23, v23, v87
    v_mul_f32 v24, v24, v87
    v_mul_f32 v25, v25, v87
    v_mul_f32 v26, v26, v87
    v_mul_f32 v27, v27, v87
    v_mul_f32 v28, v28, v87
    v_mul_f32 v29, v29, v87
    v_mul_f32 v30, v30, v87
    v_mul_f32 v31, v31, v87
    v_mul_f32 v32, v32, v87
    v_mul_f32 v33, v33, v87
    v_mul_f32 v34, v34, v87
    v_mul_f32 v35, v35, v87
    v_mul_f32 v36, v36, v87
    v_mul_f32 v37, v37, v87
    v_mul_f32 v38, v38, v87
    v_mul_f32 v39, v39, v87
    v_permlane32_swap_b32 v16, v28
    v_permlane32_swap_b32 v17, v29
    v_permlane32_swap_b32 v18, v30
    v_permlane32_swap_b32 v19, v31
    v_permlane32_swap_b32 v20, v32
    v_permlane32_swap_b32 v21, v33
    v_permlane32_swap_b32 v22, v34
    v_permlane32_swap_b32 v23, v35
    v_permlane32_swap_b32 v24, v36
    v_permlane32_swap_b32 v25, v37
    v_permlane32_swap_b32 v26, v38
    v_permlane32_swap_b32 v27, v39
    v_add_f32 v16, v16, v28
    v_add_f32 v17, v17, v29
    v_add_f32 v18, v18, v30
    v_add_f32 v19, v19, v31
    v_add_f32 v20, v20, v32
    v_add_f32 v21, v21, v33
    v_add_f32 v22, v22, v34
    v_add_f32 v23, v23, v35
    v_add_f32 v24, v24, v36
    v_add_f32 v25, v25, v37
    v_add_f32 v26, v26, v38
    v_add_f32 v27, v27, v39
    v_permlane16_swap_b32 v16, v22
    v_permlane16_swap_b32 v17, v23
    v_permlane16_swap_b32 v18, v24
    v_permlane16_swap_b32 v19, v25
    v_permlane16_swap_b32 v20, v26
    v_permlane16_swap_b32 v21, v27
    v_add_f32 v16, v16, v22
    v_add_f32 v17, v17, v23
    v_add_f32 v18, v18, v24
    v_add_f32 v19, v19, v25
    v_add_f32 v20, v20, v26
    v_add_f32 v21, v21, v27
    v_add_f32_dpp v16, v16, v16 row_ror:8 row_mask:0xf bank_mask:0x3
    v_add_f32_dpp v17, v17, v17 row_ror:8 row_mask:0xf bank_mask:0x3
    v_add_f32_dpp v18, v18, v18 row_ror:8 row_mask:0xf bank_mask:0x3
    v_add_f32_dpp v16, v19, v19 row_ror:8 row_mask:0xf bank_mask:0xc
    v_add_f32_dpp v17, v20, v20 row_ror:8 row_mask:0xf bank_mask:0xc
    v_add_f32_dpp v18, v21, v21 row_ror:8 row_mask:0xf bank_mask:0xc
    ds_write_b32 v96, v16 offset:12288
    ds_write_b32 v97, v17 offset:12288
    ds_write_b32 v98, v18 offset:12288
    v_mov_b32 v185, s52
    v_mov_b32 v187, s52
    v_mov_b32 v189, s52
    v_mov_b32 v191, s52
    v_mov_b32 v28, 0
    v_mov_b32 v29, 0
    v_mov_b32 v30, 0
    v_mov_b32 v31, 0
    v_mov_b32 v32, 0
    v_mov_b32 v33, 0
    v_mov_b32 v34, 0
    v_mov_b32 v35, 0
    s_waitcnt lgkmcnt(0)
    s_barrier
    s_cmp_lg_u32 s3, 0
    s_cbranch_scc1 L_nopub
    ds_read_b128 v[136:139], v13 offset:12288
    ds_read_b128 v[140:143], v13 offset:13056
    ds_read_b128 v[144:147], v13 offset:13824
    ds_read_b128 v[148:151], v13 offset:14592
    ds_read_b128 v[152:155], v13 offset:15360
    ds_read_b128 v[156:159], v13 offset:16128
    ds_read_b128 v[160:163], v13 offset:16896
    ds_read_b128 v[164:167], v13 offset:17664
    s_waitcnt lgkmcnt(6)
    v_add_f32 v136, v136, v140
    v_add_f32 v137, v137, v141
    v_add_f32 v138, v138, v142
    v_add_f32 v139, v139, v143
    s_waitcnt lgkmcnt(5)
    v_add_f32 v136, v136, v144
    v_add_f32 v137, v137, v145
    v_add_f32 v138, v138, v146
    v_add_f32 v139, v139, v147
    s_waitcnt lgkmcnt(4)
    v_add_f32 v136, v136, v148
    v_add_f32 v137, v137, v149
    v_add_f32 v138, v138, v150
    v_add_f32 v139, v139, v151
    s_waitcnt lgkmcnt(3)
    v_add_f32 v136, v136, v152
    v_add_f32 v137, v137, v153
    v_add_f32 v138, v138, v154
    v_add_f32 v139, v139, v155
    s_waitcnt lgkmcnt(2)
    v_add_f32 v136, v136, v156
    v_add_f32 v137, v137, v157
    v_add_f32 v138, v138, v158
    v_add_f32 v139, v139, v159
    s_waitcnt lgkmcnt(1)
    v_add_f32 v136, v136, v160
    v_add_f32 v137, v137, v161
    v_add_f32 v138, v138, v162
    v_add_f32 v139, v139, v163
    s_waitcnt lgkmcnt(0)
    v_add_f32 v136, v136, v164
    v_add_f32 v137, v137, v165
    v_add_f32 v138, v138, v166
    v_add_f32 v139, v139, v167
    v_cvt_pk_bf16_f32 v184, v136, v137
    v_cvt_pk_bf16_f32 v186, v138, v139
    s_mov_b32 exec_hi, 0xffff
    buffer_store_dwordx4 v[184:187], v13, s[24:27], s55 offen sc1
    s_mov_b64 exec, -1
L_nopub:
    s_nop 4
    s_cmp_lt_u32 s46, 3
    s_cbranch_scc1 L_ffn
    s_mov_b32 s43, 60000
L_oxp_re:
    s_nop 4
    s_mov_b32 s60, 32
L_oxp:
    s_nop 4
    buffer_load_dwordx4 v[20:23], v13, s[24:27], s56 offen sc1
    s_waitcnt vmcnt(0)
    v_xor_b32 v21, s52, v21
    v_xor_b32 v23, s52, v23
    v_or_b32 v7, v21, v23
    v_cmp_ne_u32 vcc, 0, v7
    s_nop 4
    s_cbranch_vccz L_oxp_done
    s_sleep 1
    s_sub_u32 s60, s60, 1
    s_cmp_lg_u32 s60, 0
    s_cbranch_scc1 L_oxp
    s_branch L_oxp_slow
L_oxp_done:
    s_nop 4
    ds_write2_b32 v102, v20, v22 offset0:0 offset1:1
    s_waitcnt lgkmcnt(0)
    s_barrier
    ds_read_b128 v[136:139], v100 offset:6656
    ds_read_b128 v[160:163], v100 offset:8192
    ds_read_b128 v[140:143], v100 offset:6720
    ds_read_b128 v[164:167], v100 offset:8256
    ds_read_b128 v[144:147], v100 offset:6784
    ds_read_b128 v[168:171], v100 offset:8320
    ds_read_b128 v[148:151], v100 offset:6848
    ds_read_b128 v[172:175], v100 offset:8384
    ds_read_b128 v[152:155], v100 offset:6912
    ds_read_b128 v[176:179], v100 offset:8448
    ds_read_b128 v[156:159], v100 offset:6976
    ds_read_b128 v[180:183], v100 offset:8512
    s_waitcnt lgkmcnt(11)
    v_mfma_f32_16x16x32_bf16 v[28:31], v[112:115], v[136:139], v[28:31]
    s_waitcnt lgkmcnt(10)
    v_mfma_f32_16x16x32_bf16 v[32:35], v[112:115], v[160:163], v[32:35]
    s_waitcnt lgkmcnt(9)
    v_mfma_f32_16x16x32_bf16 v[28:31], v[116:119], v[140:143], v[28:31]
    s_waitcnt lgkmcnt(8)
    v_mfma_f32_16x16x32_bf16 v[32:35], v[116:119], v[164:167], v[32:35]
    s_waitcnt lgkmcnt(7)
    v_mfma_f32_16x16x32_bf16 v[28:31], v[120:123], v[144:147], v[28:31]
    s_waitcnt lgkmcnt(6)
    v_mfma_f32_16x16x32_bf16 v[32:35], v[120:123], v[168:171], v[32:35]
    s_waitcnt lgkmcnt(5)
    v_mfma_f32_16x16x32_bf16 v[28:31], v[124:127], v[148:151], v[28:31]
    s_waitcnt lgkmcnt(4)
    v_mfma_f32_16x16x32_bf16 v[32:35], v[124:127], v[172:175], v[32:35]
    s_waitcnt lgkmcnt(3)
    v_mfma_f32_16x16x32_bf16 v[28:31], v[128:131], v[152:155], v[28:31]
    s_waitcnt lgkmcnt(2)
    v_mfma_f32_16x16x32_bf16 v[32:35], v[128:131], v[176:179], v[32:35]
    s_waitcnt lgkmcnt(1)
    v_mfma_f32_16x16x32_bf16 v[28:31], v[132:135], v[156:159], v[28:31]
    s_waitcnt lgkmcnt(0)
    v_mfma_f32_16x16x32_bf16 v[32:35], v[132:135], v[180:183], v[32:35]
    s_mov_b32 exec_lo, 0x11111111
    s_mov_b32 exec_hi, 0x11111111
    s_nop 5
    v_add_f32 v28, v28, v32
    v_add_f32 v29, v29, v33
    v_add_f32 v30, v30, v34
    v_add_f32 v31, v31, v35
    v_cvt_pk_bf16_f32 v184, v28, v29
    v_cvt_pk_bf16_f32 v186, v30, v31
    buffer_store_dwordx4 v[184:187], v101, s[24:27], s62 offen sc1
    s_mov_b64 exec, -1
    s_mul_i32 s55, s44, 5
    s_add_u32 s55, s55, s46
    s_sub_u32 s55, s55, 3
    s_cmp_lg_u32 s3, 7
    s_cbranch_scc1 L_nob1
    s_lshr_b32 s58, s55, 5
    s_bfe_u32 s59, s55, 0x20003
    s_and_b32 s63, s55, 7
    s_mul_i32 s62, s59, 640
    s_lshl_b32 s56, s58, 7
    s_add_u32 s62, s62, s56
    s_lshl_b32 s56, s63, 4
    s_add_u32 s62, s62, s56
    s_lshl_b32 s58, s58, 16
    s_and_b32 s59, s55, 31
    s_lshl_b32 s59, s59, 6
    s_add_u32 s58, s58, s59
    s_add_u32 s58, s58, 393216
    v_lshrrev_b32 v7, 2, v1
    v_lshlrev_b32 v7, 11, v7
    v_and_b32 v9, 3, v1
    v_lshl_add_u32 v7, v9, 4, v7
    v_add_u32 v8, 32768, v7
    v_lshrrev_b32 v11, 4, v1
    v_lshl_add_u32 v11, v9, 2, v11
    v_lshlrev_b32 v12, 1, v11
    v_bfe_u32 v13, v1, 2, 3
    v_mul_u32_u24 v13, 10240, v13
    v_lshrrev_b32 v11, 5, v1
    v_lshl_add_u32 v11, v9, 1, v11
    v_lshl_add_u32 v11, v11, 3, v13
    s_lshl_b32 s63, s62, 1
    v_mov_b32 v13, 0
    buffer_load_short_d16_hi v13, v12, s[20:23], s63 offen
    s_lshl_b32 s62, s62, 2
    s_add_u32 s62, s62, 73728
    s_add_u32 s63, s62, 81920
    s_mov_b32 s43, 60000
L_ypp_re:
    s_nop 4
    s_mov_b32 s60, 32
L_ypp:
    s_nop 4
    buffer_load_dwordx4 v[24:27], v7, s[24:27], s58 offen sc1
    buffer_load_dwordx4 v[28:31], v8, s[24:27], s58 offen sc1
    s_waitcnt vmcnt(0)
    v_xor_b32 v25, s52, v25
    v_xor_b32 v27, s52, v27
    v_xor_b32 v29, s52, v29
    v_xor_b32 v31, s52, v31
    v_or3_b32 v12, v25, v27, v29
    v_or_b32 v12, v12, v31
    v_cmp_ne_u32 vcc, 0, v12
    s_nop 4
    s_cbranch_vccz L_ypp_done
    s_sleep 1
    s_sub_u32 s60, s60, 1
    s_cmp_lg_u32 s60, 0
    s_cbranch_scc1 L_ypp
    s_branch L_ypp_slow
L_ypp_done:
    s_nop 4
    v_lshlrev_b32 v16, 16, v24
    v_and_b32 v17, 0xffff0000, v24
    v_lshlrev_b32 v18, 16, v26
    v_and_b32 v19, 0xffff0000, v26
    v_lshlrev_b32 v20, 16, v28
    v_and_b32 v21, 0xffff0000, v28
    v_lshlrev_b32 v22, 16, v30
    v_and_b32 v23, 0xffff0000, v30
    v_add_f32 v16, v16, v20
    v_add_f32 v17, v17, v21
    v_add_f32 v18, v18, v22
    v_add_f32 v19, v19, v23
    s_nop 0
    v_permlane32_swap_b32 v16, v18
    v_permlane32_swap_b32 v17, v19
    v_add_f32 v16, v16, v18
    v_add_f32 v17, v17, v19
    s_nop 1
    v_permlane16_swap_b32 v16, v17
    v_add_f32 v16, v16, v17
    s_nop 1
    v_add_f32_dpp v16, v16, v16 row_ror:8 row_mask:0xf bank_mask:0xf
    s_nop 1
    v_add_f32_dpp v16, v16, v16 row_ror:4 row_mask:0xf bank_mask:0xf
    v_mov_b32 v17, s52
    v_cvt_pk_bf16_f32 v16, v16, v16
    v_and_b32 v16, 0xffff0000, v16
    v_add_f32 v16, v16, v13
    v_cvt_pk_bf16_f32 v16, v16, v16
    v_and_b32 v16, 0xffff0000, v16
    v_mov_b32 v18, v16
    v_mov_b32 v19, v16
    s_nop 1
    v_permlane16_swap_b32 v18, v19
    v_cvt_pk_bf16_f32 v16, v18, v19
    buffer_store_dwordx2 v[16:17], v11, s[24:27], s62 offen sc1
    s_mov_b32 exec_lo, 0xffff
    s_mov_b32 exec_hi, 0xffff
    buffer_store_dwordx2 v[16:17], v11, s[24:27], s63 offen sc1
    s_mov_b64 exec, -1
L_nob1:
    s_nop 4
    s_cmp_lt_u32 s55, 40
    s_cbranch_scc1 L_red
    s_endpgm
L_red:
    s_nop 4
    s_lshl_b32 s62, s55, 9
    s_mul_i32 s63, s44, 10240
    s_mul_i32 s58, s3, 122880
    s_lshr_b32 s59, s62, 1
    s_add_u32 s63, s63, s59
    s_add_u32 s63, s63, 73728
    v_lshrrev_b32 v10, 1, v1
    v_lshlrev_b32 v10, 3, v10
    v_and_b32 v11, 1, v1
    v_xor_b32 v11, 1, v11
    v_lshlrev_b32 v11, 4, v11
    s_add_u32 s58, s58, s59
    s_add_u32 s58, s58, 720896
    s_add_u32 s59, s58, 20480
    s_add_u32 s56, s58, 40960
    v_lshrrev_b32 v7, 5, v1
    v_mul_u32_u24 v7, 10240, v7
    v_and_b32 v8, 31, v1
    v_lshl_add_u32 v54, v8, 3, v7
    v_add_u32 v55, 61440, v54
    s_lshl_b32 s45, s3, 8
    v_lshl_add_u32 v9, v8, 3, s45
    s_mov_b32 s43, 60000
L_hxq_re:
    s_nop 4
    s_mov_b32 s60, 32
L_hxq:
    s_nop 4
    buffer_load_dwordx2 v[52:53], v10, s[24:27], s63 offen sc1
    s_waitcnt vmcnt(0)
    v_cmp_ne_u32 vcc, s52, v53
    s_nop 4
    s_cbranch_vccz L_hxq_done
    s_sleep 4
    s_sub_u32 s60, s60, 1
    s_cmp_lg_u32 s60, 0
    s_cbranch_scc1 L_hxq
    s_branch L_hxq_slow
L_hxq_done:
    s_nop 4
    v_lshlrev_b32 v52, v11, v52
    v_and_b32 v52, 0xffff0000, v52
    s_mov_b32 s43, 60000
L_fpp_re:
    s_nop 4
    s_mov_b32 s60, 32
L_fpp:
    s_nop 4
    buffer_load_dwordx2 v[16:17], v54, s[24:27], s58 offen sc1
    buffer_load_dwordx2 v[18:19], v54, s[24:27], s59 offen sc1
    buffer_load_dwordx2 v[20:21], v54, s[24:27], s56 offen sc1
    buffer_load_dwordx2 v[22:23], v55, s[24:27], s58 offen sc1
    buffer_load_dwordx2 v[24:25], v55, s[24:27], s59 offen sc1
    buffer_load_dwordx2 v[26:27], v55, s[24:27], s56 offen sc1
    s_waitcnt vmcnt(0)
    v_xor_b32 v17, s52, v17
    v_xor_b32 v19, s52, v19
    v_xor_b32 v21, s52, v21
    v_xor_b32 v23, s52, v23
    v_xor_b32 v25, s52, v25
    v_xor_b32 v27, s52, v27
    v_or3_b32 v7, v17, v19, v21
    v_or3_b32 v7, v7, v23, v25
    v_or_b32 v7, v7, v27
    v_cmp_ne_u32 vcc, 0, v7
    s_nop 4
    s_cbranch_vccz L_fpp_done
    s_sleep 1
    s_sub_u32 s60, s60, 1
    s_cmp_lg_u32 s60, 0
    s_cbranch_scc1 L_fpp
    s_branch L_fpp_slow
L_fpp_done:
    s_nop 4
    v_and_b32 v17, 0xffff0000, v16
    v_lshlrev_b32 v16, 16, v16
    v_and_b32 v19, 0xffff0000, v18
    v_lshlrev_b32 v18, 16, v18
    v_and_b32 v21, 0xffff0000, v20
    v_lshlrev_b32 v20, 16, v20
    v_and_b32 v23, 0xffff0000, v22
    v_lshlrev_b32 v22, 16, v22
    v_and_b32 v25, 0xffff0000, v24
    v_lshlrev_b32 v24, 16, v24
    v_and_b32 v27, 0xffff0000, v26
    v_lshlrev_b32 v26, 16, v26
    v_add_f32 v16, v16, v18
    v_add_f32 v17, v17, v19
    v_add_f32 v16, v16, v20
    v_add_f32 v17, v17, v21
    v_add_f32 v16, v16, v22
    v_add_f32 v17, v17, v23
    v_add_f32 v16, v16, v24
    v_add_f32 v17, v17, v25
    v_add_f32 v16, v16, v26
    v_add_f32 v17, v17, v27
    v_mov_b32 v18, v16
    v_mov_b32 v19, v16
    s_nop 1
    v_permlane32_swap_b32 v18, v19
    v_add_f32 v16, v18, v19
    v_mov_b32 v20, v17
    v_mov_b32 v21, v17
    s_nop 1
    v_permlane32_swap_b32 v20, v21
    v_add_f32 v17, v20, v21
    ds_write_b64 v9, v[16:17] offset:10240
    s_waitcnt lgkmcnt(0)
    s_barrier
    s_cmp_lg_u32 s3, 0
    s_cbranch_scc1 L_fin
    ds_read_b32 v16, v6 offset:10240
    ds_read_b32 v17, v6 offset:10496
    ds_read_b32 v18, v6 offset:10752
    ds_read_b32 v19, v6 offset:11008
    ds_read_b32 v20, v6 offset:11264
    ds_read_b32 v21, v6 offset:11520
    ds_read_b32 v22, v6 offset:11776
    ds_read_b32 v23, v6 offset:12032
    s_lshr_b32 s62, s62, 2
    v_lshlrev_b32 v7, 1, v1
    s_waitcnt lgkmcnt(0)
    v_add_f32 v16, v16, v17
    v_add_f32 v16, v16, v18
    v_add_f32 v16, v16, v19
    v_add_f32 v16, v16, v20
    v_add_f32 v16, v16, v21
    v_add_f32 v16, v16, v22
    v_add_f32 v16, v16, v23
    v_cvt_pk_bf16_f32 v16, v16, v16
    v_and_b32 v16, 0xffff0000, v16
    v_add_f32 v16, v16, v52
    v_cvt_pk_bf16_f32 v16, v16, v16
    buffer_store_short v16, v7, s[28:31], s62 offen
    s_cmp_lg_u32 s55, 0
    s_cbranch_scc1 L_fin
    v_mov_b32 v8, s52
    v_mov_b32 v9, 0
    s_mov_b64 exec, 1
    buffer_store_dword v8, v9, s[24:27], 0 offen
L_fin:
    s_nop 4
    s_endpgm
L_ffn:
    s_nop 4
    s_lshr_b32 s51, s44, 3
    s_mul_i32 s51, s51, 3
    s_add_u32 s51, s51, s46
    s_mul_i32 s55, s57, 12
    s_add_u32 s55, s55, s51
    v_lshrrev_b32 v7, 1, v1
    v_mul_u32_u24 v7, 3072, v7
    v_and_b32 v8, 1, v1
    v_lshl_add_u32 v16, v8, 4, v7
    s_lshr_b32 s58, s3, 1
    s_mul_i32 s58, s58, 491520
    s_lshl_b32 s59, s55, 5
    s_add_u32 s58, s58, s59
    s_mul_i32 s59, s3, 5120
    s_add_u32 s59, s59, 69632
    s_mul_i32 s62, s55, 0x3334
    s_lshr_b32 s62, s62, 16
    s_mul_i32 s62, s62, 5
    s_sub_u32 s62, s55, s62
    s_mul_i32 s63, s62, 98304
    s_add_u32 s63, s63, s58
    s_lshl_b32 s56, s62, 10
    s_add_u32 s56, s56, s59
    s_mov_b32 m0, s56
    s_nop 0
    buffer_load_dwordx4 v16, s[32:35], s63 offen nt lds
    s_add_u32 s62, s62, 1
    s_cmp_eq_u32 s62, 5
    s_cselect_b32 s62, 0, s62
    s_mul_i32 s63, s62, 98304
    s_add_u32 s63, s63, s58
    s_lshl_b32 s56, s62, 10
    s_add_u32 s56, s56, s59
    s_mov_b32 m0, s56
    s_nop 0
    buffer_load_dwordx4 v16, s[32:35], s63 offen nt lds
    s_add_u32 s62, s62, 1
    s_cmp_eq_u32 s62, 5
    s_cselect_b32 s62, 0, s62
    s_mul_i32 s63, s62, 98304
    s_add_u32 s63, s63, s58
    s_lshl_b32 s56, s62, 10
    s_add_u32 s56, s56, s59
    s_mov_b32 m0, s56
    s_nop 0
    buffer_load_dwordx4 v16, s[32:35], s63 offen nt lds
    s_add_u32 s62, s62, 1
    s_cmp_eq_u32 s62, 5
    s_cselect_b32 s62, 0, s62
    s_mul_i32 s63, s62, 98304
    s_add_u32 s63, s63, s58
    s_lshl_b32 s56, s62, 10
    s_add_u32 s56, s56, s59
    s_mov_b32 m0, s56
    s_nop 0
    buffer_load_dwordx4 v16, s[32:35], s63 offen nt lds
    s_add_u32 s62, s62, 1
    s_cmp_eq_u32 s62, 5
    s_cselect_b32 s62, 0, s62
    s_mul_i32 s63, s62, 98304
    s_add_u32 s63, s63, s58
    s_lshl_b32 s56, s62, 10
    s_add_u32 s56, s56, s59
    s_mov_b32 m0, s56
    s_nop 0
    buffer_load_dwordx4 v16, s[32:35], s63 offen nt lds
    v_lshrrev_b32 v7, 4, v1
    v_bfe_u32 v8, v1, 2, 2
    v_and_b32 v9, 3, v1
    v_lshlrev_b32 v20, 8, v7
    v_lshl_add_u32 v20, v8, 5, v20
    v_lshl_add_u32 v20, v9, 3, v20
    s_mul_i32 s58, s3, 5120
    s_add_u32 s58, s58, 69632
    v_add_u32 v20, s58, v20
    v_lshl_add_u32 v21, v7, 2, v8
    v_mul_u32_u24 v21, 1280, v21
    v_lshl_add_u32 v21, v9, 3, v21
    s_mul_i32 s58, s3, 160
    v_add_u32 v21, s58, v21
    v_mul_u32_u24 v22, 1280, v8
    v_lshl_add_u32 v22, v7, 4, v22
    s_lshr_b32 s58, s3, 1
    s_mul_i32 s58, s58, 320
    v_add_u32 v22, s58, v22
    s_lshl_b32 s58, s3, 8
    v_add_u32 v23, s58, v6
    v_lshlrev_b32 v24, 6, v8
    v_lshl_add_u32 v24, v7, 4, v24
    v_lshl_add_u32 v24, v9, 2, v24
    v_add_u32 v24, 10240, v24
    v_mul_u32_u24 v25, 2560, v8
    v_lshl_add_u32 v25, v7, 4, v25
    v_lshlrev_b32 v26, 4, v1
    v_mov_b32 v116, 0
    v_mov_b32 v117, 0
    v_mov_b32 v118, 0
    v_mov_b32 v119, 0
    v_mov_b32 v120, 0
    v_mov_b32 v171, s52
    v_mov_b32 v121, 0
    v_mov_b32 v173, s52
    v_mov_b32 v122, 0
    v_mov_b32 v175, s52
    v_mov_b32 v123, 0
    v_mov_b32 v177, s52
    v_mov_b32 v124, 0
    v_mov_b32 v179, s52
    v_mov_b32 v125, 0
    v_mov_b32 v181, s52
    v_mov_b32 v126, 0
    v_mov_b32 v183, s52
    v_mov_b32 v127, 0
    v_mov_b32 v185, s52
    v_mov_b32 v128, 0
    v_mov_b32 v187, s52
    v_mov_b32 v129, 0
    v_mov_b32 v189, s52
    v_mov_b32 v130, 0
    v_mov_b32 v191, s52
    v_mov_b32 v131, 0
    v_mov_b32 v193, s52
    v_mov_b32 v132, 0
    v_mov_b32 v195, s52
    v_mov_b32 v133, 0
    v_mov_b32 v197, s52
    v_mov_b32 v134, 0
    v_mov_b32 v199, s52
    v_mov_b32 v135, 0
    v_mov_b32 v201, s52
    v_mov_b32 v136, 0
    v_mov_b32 v203, s52
    v_mov_b32 v137, 0
    v_mov_b32 v205, s52
    v_mov_b32 v138, 0
    v_mov_b32 v207, s52
    v_mov_b32 v139, 0
    v_mov_b32 v209, s52
    s_mul_i32 s62, s55, 10240
    s_mul_i32 s59, s3, 320
    s_add_u32 s62, s62, s59
    s_add_u32 s62, s62, 720896
    s_mul_i32 s58, s3, 2560
    s_mul_i32 s59, s51, 10240
    s_add_u32 s58, s58, s59
    s_add_u32 s58, s58, 73728
    v_mov_b32 v7, 9728
L_wdspin:
    s_nop 4
    ds_read_b32 v8, v7
    s_waitcnt lgkmcnt(0)
    v_readfirstlane_b32 s58, v8
    s_nop 1
    s_cmp_ge_u32 s58, 8
    s_cbranch_scc1 L_wdspin_ok
    s_sleep 1
    s_branch L_wdspin
L_wdspin_ok:
    s_nop 4
    ds_read_b64_tr_b16 v[160:161], v21 offset:36864
    ds_read_b64_tr_b16 v[162:163], v21 offset:36896
    ds_read_b64_tr_b16 v[164:165], v21 offset:36928
    ds_read_b64_tr_b16 v[166:167], v21 offset:36960
    ds_read_b64_tr_b16 v[168:169], v21 offset:36992
    s_mul_i32 s58, s3, 2560
    s_mul_i32 s59, s51, 10240
    s_add_u32 s58, s58, s59
    s_add_u32 s58, s58, 73728
    s_mul_i32 s59, s3, 1280
    s_waitcnt vmcnt(0)
    ds_read_b64_tr_b16 v[140:141], v20 offset:0
    ds_read_b64_tr_b16 v[142:143], v20 offset:128
    ds_read_b64_tr_b16 v[144:145], v20 offset:1024
    ds_read_b64_tr_b16 v[146:147], v20 offset:1152
    ds_read_b64_tr_b16 v[148:149], v20 offset:2048
    ds_read_b64_tr_b16 v[150:151], v20 offset:2176
    ds_read_b64_tr_b16 v[152:153], v20 offset:3072
    ds_read_b64_tr_b16 v[154:155], v20 offset:3200
    ds_read_b64_tr_b16 v[156:157], v20 offset:4096
    ds_read_b64_tr_b16 v[158:159], v20 offset:4224
    s_waitcnt lgkmcnt(0)
    s_cmp_ge_u32 s3, 4
    s_cbranch_scc1 L_noln
    s_mov_b32 s43, 60000
L_hxp_re:
    s_nop 4
    s_mov_b32 s60, 32
L_hxp:
    s_nop 4
    buffer_load_dwordx2 v[32:33], v5, s[24:27], s58 offen offset:0 sc1
    buffer_load_dwordx2 v[34:35], v5, s[24:27], s58 offen offset:512 sc1
    buffer_load_dwordx2 v[36:37], v5, s[24:27], s58 offen offset:1024 sc1
    buffer_load_dwordx2 v[38:39], v5, s[24:27], s58 offen offset:1536 sc1
    buffer_load_dwordx2 v[40:41], v5, s[24:27], s58 offen offset:2048 sc1
    s_waitcnt vmcnt(0)
    v_xor_b32 v33, s52, v33
    v_xor_b32 v35, s52, v35
    v_xor_b32 v37, s52, v37
    v_xor_b32 v39, s52, v39
    v_xor_b32 v41, s52, v41
    v_or3_b32 v7, v33, v35, v37
    v_or3_b32 v7, v7, v39, v41
    v_cmp_ne_u32 vcc, 0, v7
    s_nop 4
    s_cbranch_vccz L_hxp_done
    s_sleep 1
    s_sub_u32 s60, s60, 1
    s_cmp_lg_u32 s60, 0
    s_cbranch_scc1 L_hxp
    s_branch L_hxp_slow
L_hxp_done:
    s_nop 4
    v_and_b32 v33, 0xffff0000, v32
    v_lshlrev_b32 v32, 16, v32
    v_and_b32 v35, 0xffff0000, v34
    v_lshlrev_b32 v34, 16, v34
    v_and_b32 v37, 0xffff0000, v36
    v_lshlrev_b32 v36, 16, v36
    v_and_b32 v39, 0xffff0000, v38
    v_lshlrev_b32 v38, 16, v38
    v_and_b32 v41, 0xffff0000, v40
    v_lshlrev_b32 v40, 16, v40
    v_add_f32 v56, v32, v33
    v_add_f32 v56, v56, v34
    v_add_f32 v56, v56, v35
    v_add_f32 v56, v56, v36
    v_add_f32 v56, v56, v37
    v_add_f32 v56, v56, v38
    v_add_f32 v56, v56, v39
    v_add_f32 v56, v56, v40
    v_add_f32 v56, v56, v41
    s_nop 1
    v_add_f32_dpp v56, v56, v56 quad_perm:[1,0,3,2] row_mask:0xf bank_mask:0xf
    s_nop 1
    v_add_f32_dpp v56, v56, v56 quad_perm:[2,3,0,1] row_mask:0xf bank_mask:0xf
    s_nop 1
    v_add_f32_dpp v56, v56, v56 row_half_mirror row_mask:0xf bank_mask:0xf
    s_nop 1
    v_add_f32_dpp v56, v56, v56 row_mirror row_mask:0xf bank_mask:0xf
    v_mov_b32 v57, v56
    v_mov_b32 v58, v56
    s_nop 1
    v_permlane16_swap_b32 v57, v58
    v_add_f32 v56, v57, v58
    v_mov_b32 v57, v56
    v_mov_b32 v58, v56
    s_nop 1
    v_permlane32_swap_b32 v57, v58
    v_add_f32 v56, v57, v58
    v_mul_f32 v56, 0x3acccccd, v56
    v_sub_f32 v57, v32, v56
    v_mul_f32 v59, v57, v57
    v_sub_f32 v57, v33, v56
    v_fmac_f32 v59, v57, v57
    v_sub_f32 v57, v34, v56
    v_fmac_f32 v59, v57, v57
    v_sub_f32 v57, v35, v56
    v_fmac_f32 v59, v57, v57
    v_sub_f32 v57, v36, v56
    v_fmac_f32 v59, v57, v57
    v_sub_f32 v57, v37, v56
    v_fmac_f32 v59, v57, v57
    v_sub_f32 v57, v38, v56
    v_fmac_f32 v59, v57, v57
    v_sub_f32 v57, v39, v56
    v_fmac_f32 v59, v57, v57
    v_sub_f32 v57, v40, v56
    v_fmac_f32 v59, v57, v57
    v_sub_f32 v57, v41, v56
    v_fmac_f32 v59, v57, v57
    s_nop 1
    v_add_f32_dpp v59, v59, v59 quad_perm:[1,0,3,2] row_mask:0xf bank_mask:0xf
    s_nop 1
    v_add_f32_dpp v59, v59, v59 quad_perm:[2,3,0,1] row_mask:0xf bank_mask:0xf
    s_nop 1
    v_add_f32_dpp v59, v59, v59 row_half_mirror row_mask:0xf bank_mask:0xf
    s_nop 1
    v_add_f32_dpp v59, v59, v59 row_mirror row_mask:0xf bank_mask:0xf
    v_mov_b32 v57, v59
    v_mov_b32 v58, v59
    s_nop 1
    v_permlane16_swap_b32 v57, v58
    v_add_f32 v59, v57, v58
    v_mov_b32 v57, v59
    v_mov_b32 v58, v59
    s_nop 1
    v_permlane32_swap_b32 v57, v58
    v_add_f32 v59, v57, v58
    v_mul_f32 v59, 0x3acccccd, v59
    v_cvt_pk_bf16_f32 v56, v56, v56
    v_and_b32 v56, 0xffff0000, v56
    v_cvt_pk_bf16_f32 v59, v59, v59
    v_and_b32 v59, 0xffff0000, v59
    v_add_f32 v59, 0x3727c5ac, v59
    v_cvt_pk_bf16_f32 v59, v59, v59
    v_and_b32 v59, 0xffff0000, v59
    v_sqrt_f32 v59, v59
    s_nop 0
    v_cvt_pk_bf16_f32 v59, v59, v59
    v_and_b32 v59, 0xffff0000, v59
    v_rcp_f32 v59, v59
    v_add_u32 v57, s59, v6
    v_sub_f32 v32, v32, v56
    v_sub_f32 v33, v33, v56
    v_sub_f32 v34, v34, v56
    v_sub_f32 v35, v35, v56
    v_sub_f32 v36, v36, v56
    v_sub_f32 v37, v37, v56
    v_sub_f32 v38, v38, v56
    v_sub_f32 v39, v39, v56
    v_sub_f32 v40, v40, v56
    v_sub_f32 v41, v41, v56
    v_cvt_pk_bf16_f32 v32, v32, v32
    v_and_b32 v32, 0xffff0000, v32
    v_cvt_pk_bf16_f32 v33, v33, v33
    v_and_b32 v33, 0xffff0000, v33
    v_cvt_pk_bf16_f32 v34, v34, v34
    v_and_b32 v34, 0xffff0000, v34
    v_cvt_pk_bf16_f32 v35, v35, v35
    v_and_b32 v35, 0xffff0000, v35
    v_cvt_pk_bf16_f32 v36, v36, v36
    v_and_b32 v36, 0xffff0000, v36
    v_cvt_pk_bf16_f32 v37, v37, v37
    v_and_b32 v37, 0xffff0000, v37
    v_cvt_pk_bf16_f32 v38, v38, v38
    v_and_b32 v38, 0xffff0000, v38
    v_cvt_pk_bf16_f32 v39, v39, v39
    v_and_b32 v39, 0xffff0000, v39
    v_cvt_pk_bf16_f32 v40, v40, v40
    v_and_b32 v40, 0xffff0000, v40
    v_cvt_pk_bf16_f32 v41, v41, v41
    v_and_b32 v41, 0xffff0000, v41
    v_mul_f32 v32, v32, v59
    v_mul_f32 v33, v33, v59
    v_mul_f32 v34, v34, v59
    v_mul_f32 v35, v35, v59
    v_mul_f32 v36, v36, v59
    v_mul_f32 v37, v37, v59
    v_mul_f32 v38, v38, v59
    v_mul_f32 v39, v39, v59
    v_mul_f32 v40, v40, v59
    v_mul_f32 v41, v41, v59
    v_cvt_pk_bf16_f32 v32, v32, v33
    ds_write_b32 v57, v32 offset:0
    v_cvt_pk_bf16_f32 v34, v34, v35
    ds_write_b32 v57, v34 offset:256
    v_cvt_pk_bf16_f32 v36, v36, v37
    ds_write_b32 v57, v36 offset:512
    v_cvt_pk_bf16_f32 v38, v38, v39
    ds_write_b32 v57, v38 offset:768
    v_cvt_pk_bf16_f32 v40, v40, v41
    ds_write_b32 v57, v40 offset:1024
    s_waitcnt lgkmcnt(0)
L_noln:
    s_nop 4
    s_barrier
    ds_read_b128 v[96:99], v22 offset:0
    ds_read_b128 v[100:103], v22 offset:64
    ds_read_b128 v[104:107], v22 offset:128
    ds_read_b128 v[108:111], v22 offset:192
    ds_read_b128 v[112:115], v22 offset:256
    s_waitcnt lgkmcnt(4)
    v_mfma_f32_16x16x32_bf16 v[116:119], v[96:99], v[140:143], v[116:119]
    s_waitcnt lgkmcnt(3)
    v_mfma_f32_16x16x32_bf16 v[116:119], v[100:103], v[144:147], v[116:119]
    s_waitcnt lgkmcnt(2)
    v_mfma_f32_16x16x32_bf16 v[116:119], v[104:107], v[148:151], v[116:119]
    s_waitcnt lgkmcnt(1)
    v_mfma_f32_16x16x32_bf16 v[116:119], v[108:111], v[152:155], v[116:119]
    s_waitcnt lgkmcnt(0)
    v_mfma_f32_16x16x32_bf16 v[116:119], v[112:115], v[156:159], v[116:119]
    s_nop 7
    ds_write_b32 v23, v116 offset:10240
    s_waitcnt lgkmcnt(0)
    s_barrier
    ds_read2_b32 v[32:33], v24 offset0:0 offset1:64
    ds_read2_b32 v[34:35], v24 offset0:128 offset1:192
    v_add_u32 v7, 1024, v24
    ds_read2_b32 v[36:37], v7 offset0:0 offset1:64
    ds_read2_b32 v[38:39], v7 offset0:128 offset1:192
    s_waitcnt lgkmcnt(0)
    v_add_f32 v28, v32, v34
    v_add_f32 v29, v33, v35
    v_add_f32 v30, v36, v38
    v_add_f32 v31, v37, v39
    v_add_f32 v28, v28, v30
    v_add_f32 v29, v29, v31
    v_cvt_pk_bf16_f32 v28, v28, v28
    v_and_b32 v28, 0xffff0000, v28
    v_cvt_pk_bf16_f32 v29, v29, v29
    v_and_b32 v29, 0xffff0000, v29
    v_mul_f32 v30, 0xbfb8aa3b, v28
    v_exp_f32 v30, v30
    s_nop 0
    v_add_f32 v30, 1.0, v30
    v_rcp_f32 v30, v30
    s_nop 0
    v_mul_f32 v28, v28, v30
    v_cvt_pk_bf16_f32 v28, v28, v28
    v_and_b32 v28, 0xffff0000, v28
    v_mul_f32 v28, v28, v29
    s_nop 1
    v_mov_b32_dpp v32, v28 quad_perm:[0,0,0,0] row_mask:0xf bank_mask:0xf
    v_mov_b32_dpp v33, v28 quad_perm:[1,1,1,1] row_mask:0xf bank_mask:0xf
    v_mov_b32_dpp v34, v28 quad_perm:[2,2,2,2] row_mask:0xf bank_mask:0xf
    v_mov_b32_dpp v35, v28 quad_perm:[3,3,3,3] row_mask:0xf bank_mask:0xf
    v_cvt_pk_bf16_f32 v30, v32, v33
    v_cvt_pk_bf16_f32 v31, v34, v35
    s_nop 1
    v_mfma_f32_16x16x16_bf16 v[120:123], v[160:161], v[30:31], v[120:123]
    v_mfma_f32_16x16x16_bf16 v[124:127], v[162:163], v[30:31], v[124:127]
    v_mfma_f32_16x16x16_bf16 v[128:131], v[164:165], v[30:31], v[128:131]
    v_mfma_f32_16x16x16_bf16 v[132:135], v[166:167], v[30:31], v[132:135]
    v_mfma_f32_16x16x16_bf16 v[136:139], v[168:169], v[30:31], v[136:139]
    s_mov_b32 exec_lo, 0x11111111
    s_mov_b32 exec_hi, 0x11111111
    s_nop 1
    v_cvt_pk_bf16_f32 v170, v120, v121
    v_cvt_pk_bf16_f32 v172, v122, v123
    buffer_store_dwordx4 v[170:173], v25, s[24:27], s62 offen offset:0 sc1
    v_cvt_pk_bf16_f32 v174, v124, v125
    v_cvt_pk_bf16_f32 v176, v126, v127
    buffer_store_dwordx4 v[174:177], v25, s[24:27], s62 offen offset:64 sc1
    v_cvt_pk_bf16_f32 v178, v128, v129
    v_cvt_pk_bf16_f32 v180, v130, v131
    buffer_store_dwordx4 v[178:181], v25, s[24:27], s62 offen offset:128 sc1
    v_cvt_pk_bf16_f32 v182, v132, v133
    v_cvt_pk_bf16_f32 v184, v134, v135
    buffer_store_dwordx4 v[182:185], v25, s[24:27], s62 offen offset:192 sc1
    v_cvt_pk_bf16_f32 v186, v136, v137
    v_cvt_pk_bf16_f32 v188, v138, v139
    buffer_store_dwordx4 v[186:189], v25, s[24:27], s62 offen offset:256 sc1
    s_endpgm
L_qsum:
    s_nop 4
    ds_read_b128 v[16:19], v13 offset:12288
    ds_read_b128 v[20:23], v13 offset:13056
    ds_read_b128 v[24:27], v13 offset:13824
    ds_read_b128 v[28:31], v13 offset:14592
    ds_read_b128 v[32:35], v13 offset:15360
    ds_read_b128 v[36:39], v13 offset:16128
    ds_read_b128 v[40:43], v13 offset:16896
    ds_read_b128 v[44:47], v13 offset:17664
    s_waitcnt lgkmcnt(6)
    v_add_f32 v16, v16, v20
    v_add_f32 v17, v17, v21
    v_add_f32 v18, v18, v22
    v_add_f32 v19, v19, v23
    s_waitcnt lgkmcnt(5)
    v_add_f32 v16, v16, v24
    v_add_f32 v17, v17, v25
    v_add_f32 v18, v18, v26
    v_add_f32 v19, v19, v27
    s_waitcnt lgkmcnt(4)
    v_add_f32 v16, v16, v28
    v_add_f32 v17, v17, v29
    v_add_f32 v18, v18, v30
    v_add_f32 v19, v19, v31
    s_waitcnt lgkmcnt(3)
    v_add_f32 v16, v16, v32
    v_add_f32 v17, v17, v33
    v_add_f32 v18, v18, v34
    v_add_f32 v19, v19, v35
    s_waitcnt lgkmcnt(2)
    v_add_f32 v16, v16, v36
    v_add_f32 v17, v17, v37
    v_add_f32 v18, v18, v38
    v_add_f32 v19, v19, v39
    s_waitcnt lgkmcnt(1)
    v_add_f32 v16, v16, v40
    v_add_f32 v17, v17, v41
    v_add_f32 v18, v18, v42
    v_add_f32 v19, v19, v43
    s_waitcnt lgkmcnt(0)
    v_add_f32 v16, v16, v44
    v_add_f32 v17, v17, v45
    v_add_f32 v18, v18, v46
    v_add_f32 v19, v19, v47
    v_cvt_pk_bf16_f32 v48, v16, v17
    v_cvt_pk_bf16_f32 v49, v18, v19
    v_lshrrev_b32 v7, 1, v13
    ds_write_b64 v7, v[48:49] offset:5120
    s_waitcnt lgkmcnt(0)
    v_mov_b32 v7, 9736
    v_mov_b32 v8, 1
    s_waitcnt lgkmcnt(0)
    ds_write_b32 v7, v8
    s_waitcnt lgkmcnt(0)
    s_setpc_b64 s[92:93]
L_qspin_slow:
    s_nop 4
    s_sleep 8
    buffer_inv sc1
    buffer_load_dword v108, v109, s[24:27], s45 offen sc1 nt
    s_waitcnt vmcnt(0)
    v_cmp_ne_u32 vcc, s52, v108
    s_nop 4
    s_cbranch_vccz L_qspin_done
    s_sub_u32 s43, s43, 1
    s_cmp_lg_u32 s43, 0
    s_cbranch_scc1 L_qspin_re
    s_branch L_qspin_done
L_stspin_slow:
    s_nop 4
    s_sleep 8
    buffer_inv sc1
    buffer_load_dwordx4 v[44:47], v103, s[24:27], s65 offen sc1 nt
    s_waitcnt vmcnt(0)
    v_xor_b32 v45, s52, v45
    v_xor_b32 v47, s52, v47
    v_or_b32 v7, v45, v47
    v_cmp_ne_u32 vcc, 0, v7
    s_nop 4
    s_cbranch_vccz L_stspin_done
    s_sub_u32 s43, s43, 1
    s_cmp_lg_u32 s43, 0
    s_cbranch_scc1 L_stspin_re
    s_branch L_stspin_done
L_sbad0:
    s_nop 4
    s_mov_b32 s43, 960000
L_sbad0_l:
    s_nop 4
    s_sleep 8
    buffer_load_dwordx2 v[248:249], v89, s[24:27], s94 offen sc1 nt
    s_waitcnt vmcnt(0)
    v_cmp_ne_u32 vcc, s52, v249
    s_nop 4
    s_cbranch_vccz L_sok0
    s_sub_u32 s43, s43, 1
    s_cmp_lg_u32 s43, 0
    s_cbranch_scc1 L_sbad0_l
    s_branch L_sok0
L_cbad0:
    s_nop 4
    s_mov_b32 s43, 960000
L_cbad0_l:
    s_nop 4
    s_sleep 8
    v_mov_b32 v252, s100
    v_mov_b32 v253, 0
    s_mov_b64 exec, 1
    buffer_atomic_add_x2 v[252:253], v88, s[24:27], s50 offen sc0
    s_mov_b64 exec, -1
    s_waitcnt vmcnt(0)
    v_readfirstlane_b32 s58, v252
    v_readfirstlane_b32 s59, v253
    s_nop 1
    s_cmp_eq_u32 s59, s52
    s_cbranch_scc1 L_cok0
    s_sub_u32 s43, s43, 1
    s_cmp_lg_u32 s43, 0
    s_cbranch_scc1 L_cbad0_l
    s_movk_i32 s58, 96
    s_branch L_cok0
L_sbad1:
    s_nop 4
    s_mov_b32 s43, 960000
L_sbad1_l:
    s_nop 4
    s_sleep 8
    buffer_load_dwordx2 v[250:251], v89, s[24:27], s95 offen sc1 nt
    s_waitcnt vmcnt(0)
    v_cmp_ne_u32 vcc, s52, v251
    s_nop 4
    s_cbranch_vccz L_sok1
    s_sub_u32 s43, s43, 1
    s_cmp_lg_u32 s43, 0
    s_cbranch_scc1 L_sbad1_l
    s_branch L_sok1
L_cbad1:
    s_nop 4
    s_mov_b32 s43, 960000
L_cbad1_l:
    s_nop 4
    s_sleep 8
    v_mov_b32 v254, s101
    v_mov_b32 v255, 0
    s_mov_b64 exec, 1
    buffer_atomic_add_x2 v[254:255], v88, s[24:27], s50 offen sc0
    s_mov_b64 exec, -1
    s_waitcnt vmcnt(0)
    v_readfirstlane_b32 s58, v254
    v_readfirstlane_b32 s59, v255
    s_nop 1
    s_cmp_eq_u32 s59, s52
    s_cbranch_scc1 L_cok1
    s_sub_u32 s43, s43, 1
    s_cmp_lg_u32 s43, 0
    s_cbranch_scc1 L_cbad1_l
    s_movk_i32 s58, 96
    s_branch L_cok1
L_sbad2:
    s_nop 4
    s_mov_b32 s43, 960000
L_sbad2_l:
    s_nop 4
    s_sleep 8
    buffer_load_dwordx2 v[248:249], v89, s[24:27], s94 offen sc1 nt
    s_waitcnt vmcnt(0)
    v_cmp_ne_u32 vcc, s52, v249
    s_nop 4
    s_cbranch_vccz L_sok2
    s_sub_u32 s43, s43, 1
    s_cmp_lg_u32 s43, 0
    s_cbranch_scc1 L_sbad2_l
    s_branch L_sok2
L_cbad2:
    s_nop 4
    s_mov_b32 s43, 960000
L_cbad2_l:
    s_nop 4
    s_sleep 8
    v_mov_b32 v110, s91
    v_mov_b32 v111, 0
    s_mov_b64 exec, 1
    buffer_atomic_add_x2 v[110:111], v88, s[24:27], s50 offen sc0
    s_mov_b64 exec, -1
    s_waitcnt vmcnt(0)
    v_readfirstlane_b32 s58, v110
    v_readfirstlane_b32 s59, v111
    s_nop 1
    s_cmp_eq_u32 s59, s52
    s_cbranch_scc1 L_cok2
    s_sub_u32 s43, s43, 1
    s_cmp_lg_u32 s43, 0
    s_cbranch_scc1 L_cbad2_l
    s_movk_i32 s58, 96
    s_branch L_cok2
L_sbad3:
    s_nop 4
    s_mov_b32 s43, 960000
L_sbad3_l:
    s_nop 4
    s_sleep 8
    buffer_load_dwordx2 v[250:251], v89, s[24:27], s95 offen sc1 nt
    s_waitcnt vmcnt(0)
    v_cmp_ne_u32 vcc, s52, v251
    s_nop 4
    s_cbranch_vccz L_sok3
    s_sub_u32 s43, s43, 1
    s_cmp_lg_u32 s43, 0
    s_cbranch_scc1 L_sbad3_l
    s_branch L_sok3
L_cbad3:
    s_nop 4
    s_mov_b32 s43, 960000
L_cbad3_l:
    s_nop 4
    s_sleep 8
    v_mov_b32 v252, s100
    v_mov_b32 v253, 0
    s_mov_b64 exec, 1
    buffer_atomic_add_x2 v[252:253], v88, s[24:27], s50 offen sc0
    s_mov_b64 exec, -1
    s_waitcnt vmcnt(0)
    v_readfirstlane_b32 s58, v252
    v_readfirstlane_b32 s59, v253
    s_nop 1
    s_cmp_eq_u32 s59, s52
    s_cbranch_scc1 L_cok3
    s_sub_u32 s43, s43, 1
    s_cmp_lg_u32 s43, 0
    s_cbranch_scc1 L_cbad3_l
    s_movk_i32 s58, 96
    s_branch L_cok3
L_sbad4:
    s_nop 4
    s_mov_b32 s43, 960000
L_sbad4_l:
    s_nop 4
    s_sleep 8
    buffer_load_dwordx2 v[248:249], v89, s[24:27], s94 offen sc1 nt
    s_waitcnt vmcnt(0)
    v_cmp_ne_u32 vcc, s52, v249
    s_nop 4
    s_cbranch_vccz L_sok4
    s_sub_u32 s43, s43, 1
    s_cmp_lg_u32 s43, 0
    s_cbranch_scc1 L_sbad4_l
    s_branch L_sok4
L_cbad4:
    s_nop 4
    s_mov_b32 s43, 960000
L_cbad4_l:
    s_nop 4
    s_sleep 8
    v_mov_b32 v254, s101
    v_mov_b32 v255, 0
    s_mov_b64 exec, 1
    buffer_atomic_add_x2 v[254:255], v88, s[24:27], s50 offen sc0
    s_mov_b64 exec, -1
    s_waitcnt vmcnt(0)
    v_readfirstlane_b32 s58, v254
    v_readfirstlane_b32 s59, v255
    s_nop 1
    s_cmp_eq_u32 s59, s52
    s_cbranch_scc1 L_cok4
    s_sub_u32 s43, s43, 1
    s_cmp_lg_u32 s43, 0
    s_cbranch_scc1 L_cbad4_l
    s_movk_i32 s58, 96
    s_branch L_cok4
L_sbad5:
    s_nop 4
    s_mov_b32 s43, 960000
L_sbad5_l:
    s_nop 4
    s_sleep 8
    buffer_load_dwordx2 v[250:251], v89, s[24:27], s95 offen sc1 nt
    s_waitcnt vmcnt(0)
    v_cmp_ne_u32 vcc, s52, v251
    s_nop 4
    s_cbranch_vccz L_sok5
    s_sub_u32 s43, s43, 1
    s_cmp_lg_u32 s43, 0
    s_cbranch_scc1 L_sbad5_l
    s_branch L_sok5
L_cbad5:
    s_nop 4
    s_mov_b32 s43, 960000
L_cbad5_l:
    s_nop 4
    s_sleep 8
    v_mov_b32 v110, s91
    v_mov_b32 v111, 0
    s_mov_b64 exec, 1
    buffer_atomic_add_x2 v[110:111], v88, s[24:27], s50 offen sc0
    s_mov_b64 exec, -1
    s_waitcnt vmcnt(0)
    v_readfirstlane_b32 s58, v110
    v_readfirstlane_b32 s59, v111
    s_nop 1
    s_cmp_eq_u32 s59, s52
    s_cbranch_scc1 L_cok5
    s_sub_u32 s43, s43, 1
    s_cmp_lg_u32 s43, 0
    s_cbranch_scc1 L_cbad5_l
    s_movk_i32 s58, 96
    s_branch L_cok5
L_oxp_slow:
    s_nop 4
    s_sleep 8
    buffer_inv sc1
    buffer_load_dwordx4 v[20:23], v13, s[24:27], s56 offen sc1 nt
    s_waitcnt vmcnt(0)
    v_xor_b32 v21, s52, v21
    v_xor_b32 v23, s52, v23
    v_or_b32 v7, v21, v23
    v_cmp_ne_u32 vcc, 0, v7
    s_nop 4
    s_cbranch_vccz L_oxp_done
    s_sub_u32 s43, s43, 1
    s_cmp_lg_u32 s43, 0
    s_cbranch_scc1 L_oxp_re
    s_branch L_oxp_done
L_ypp_slow:
    s_nop 4
    s_sleep 8
    buffer_inv sc1
    buffer_load_dwordx4 v[24:27], v7, s[24:27], s58 offen sc1 nt
    buffer_load_dwordx4 v[28:31], v8, s[24:27], s58 offen sc1 nt
    s_waitcnt vmcnt(0)
    v_xor_b32 v25, s52, v25
    v_xor_b32 v27, s52, v27
    v_xor_b32 v29, s52, v29
    v_xor_b32 v31, s52, v31
    v_or3_b32 v12, v25, v27, v29
    v_or_b32 v12, v12, v31
    v_cmp_ne_u32 vcc, 0, v12
    s_nop 4
    s_cbranch_vccz L_ypp_done
    s_sub_u32 s43, s43, 1
    s_cmp_lg_u32 s43, 0
    s_cbranch_scc1 L_ypp_re
    s_branch L_ypp_done
L_hxq_slow:
    s_nop 4
    s_sleep 8
    buffer_inv sc1
    buffer_load_dwordx2 v[52:53], v10, s[24:27], s63 offen sc1 nt
    s_waitcnt vmcnt(0)
    v_cmp_ne_u32 vcc, s52, v53
    s_nop 4
    s_cbranch_vccz L_hxq_done
    s_sub_u32 s43, s43, 1
    s_cmp_lg_u32 s43, 0
    s_cbranch_scc1 L_hxq_re
    s_branch L_hxq_done
L_fpp_slow:
    s_nop 4
    s_sleep 8
    buffer_inv sc1
    buffer_load_dwordx2 v[16:17], v54, s[24:27], s58 offen sc1 nt
    buffer_load_dwordx2 v[18:19], v54, s[24:27], s59 offen sc1 nt
    buffer_load_dwordx2 v[20:21], v54, s[24:27], s56 offen sc1 nt
    buffer_load_dwordx2 v[22:23], v55, s[24:27], s58 offen sc1 nt
    buffer_load_dwordx2 v[24:25], v55, s[24:27], s59 offen sc1 nt
    buffer_load_dwordx2 v[26:27], v55, s[24:27], s56 offen sc1 nt
    s_waitcnt vmcnt(0)
    v_xor_b32 v17, s52, v17
    v_xor_b32 v19, s52, v19
    v_xor_b32 v21, s52, v21
    v_xor_b32 v23, s52, v23
    v_xor_b32 v25, s52, v25
    v_xor_b32 v27, s52, v27
    v_or3_b32 v7, v17, v19, v21
    v_or3_b32 v7, v7, v23, v25
    v_or_b32 v7, v7, v27
    v_cmp_ne_u32 vcc, 0, v7
    s_nop 4
    s_cbranch_vccz L_fpp_done
    s_sub_u32 s43, s43, 1
    s_cmp_lg_u32 s43, 0
    s_cbranch_scc1 L_fpp_re
    s_branch L_fpp_done
L_hxp_slow:
    s_nop 4
    s_sleep 8
    buffer_inv sc1
    buffer_load_dwordx2 v[32:33], v5, s[24:27], s58 offen offset:0 sc1 nt
    buffer_load_dwordx2 v[34:35], v5, s[24:27], s58 offen offset:512 sc1 nt
    buffer_load_dwordx2 v[36:37], v5, s[24:27], s58 offen offset:1024 sc1 nt
    buffer_load_dwordx2 v[38:39], v5, s[24:27], s58 offen offset:1536 sc1 nt
    buffer_load_dwordx2 v[40:41], v5, s[24:27], s58 offen offset:2048 sc1 nt
    s_waitcnt vmcnt(0)
    v_xor_b32 v33, s52, v33
    v_xor_b32 v35, s52, v35
    v_xor_b32 v37, s52, v37
    v_xor_b32 v39, s52, v39
    v_xor_b32 v41, s52, v41
    v_or3_b32 v7, v33, v35, v37
    v_or3_b32 v7, v7, v39, v41
    v_cmp_ne_u32 vcc, 0, v7
    s_nop 4
    s_cbranch_vccz L_hxp_done
    s_sub_u32 s43, s43, 1
    s_cmp_lg_u32 s43, 0
    s_cbranch_scc1 L_hxp_re
    s_branch L_hxp_done
L_end:
    s_nop 4
    s_endpgm

.section .rodata,"a"
.p2align 6
.amdhsa_kernel sequential_preLN__gqa_block_cached__swiglu_ffn__decode_kernel
  .amdhsa_next_free_vgpr 256
  .amdhsa_next_free_sgpr 102
  .amdhsa_accum_offset 256
  .amdhsa_group_segment_fixed_size 0
  .amdhsa_kernarg_size 96
  .amdhsa_user_sgpr_count 2
  .amdhsa_user_sgpr_kernarg_segment_ptr 1
  .amdhsa_system_sgpr_workgroup_id_x 1
.end_amdhsa_kernel
```
